```python
import torch

def _softmax(x, axis=-1):
    return torch.softmax(x, dim=axis)
def _gelu(x):
    return torch.nn.functional.gelu(x, approximate="tanh")
def _silu(x):
    return torch.nn.functional.silu(x)
def _sigmoid(x):
    return torch.sigmoid(x)
def _layernorm(x, axis=-1, eps=1e-5):
    m = x.mean(dim=axis, keepdim=True)
    v = x.var(dim=axis, keepdim=True, unbiased=False)
    return (x - m) / torch.sqrt(v + eps)
def _scatter_add(tgt, idx, src, axis=0):
    return tgt.clone().index_add_(axis, idx, src)
def _segment_sum(src, seg, n):
    out = torch.zeros((n,) + src.shape[1:], dtype=src.dtype)
    return out.index_add_(0, seg, src)
def _pad(x, pw):
    flat = tuple(v for pair in reversed(pw) for v in pair)
    return torch.nn.functional.pad(x, flat)

kernel_name = 'sequential_preLN__spectral_fnet__swiglu_ffn__prompt'

def setup_inputs():

    _w = (lambda a: (lambda t: t.to(torch.bfloat16) if t.is_floating_point() else t)(torch.as_tensor(a)))
    def _A_setup():
        B, S, D = 1, 2048, 512
        ns = torch.arange(S)[:, None] * torch.arange(S)[None, :]
        nd = torch.arange(D)[:, None] * torch.arange(D)[None, :]
        Ws_re = torch.cos(-2.0 * torch.pi * ns / S).to(float)
        Ws_im = torch.sin(-2.0 * torch.pi * ns / S).to(float)
        Wd_re = torch.cos(-2.0 * torch.pi * nd / D).to(float)
        Wd_im = torch.sin(-2.0 * torch.pi * nd / D).to(float)
        return {
            "x": _w((lambda *s: torch.randn(*s, dtype=torch.bfloat16) * 0.05)(B, S, D)),
            "dft_seq_re": _w(Ws_re),
            "dft_seq_im": _w(Ws_im),
            "dft_hid_re": _w(Wd_re),
            "dft_hid_im": _w(Wd_im),
        }
    _A_in = _A_setup()

    def _B_setup():
        B, S, D, F = 1, 2048, 512, 1376
        return {
            "x": _w((lambda *s: torch.randn(*s, dtype=torch.bfloat16) * 0.05)(B, S, D)),
            "w_gate": _w((lambda *s: torch.randn(*s, dtype=torch.bfloat16) * 0.2)(D, F)),
            "w_up": _w((lambda *s: torch.randn(*s, dtype=torch.bfloat16) * 0.2)(D, F)),
            "w_down": _w((lambda *s: torch.randn(*s, dtype=torch.bfloat16) * 0.2)(F, D)),
        }
    _B_in = _B_setup()

    return {
        "A_x": _A_in["x"],
        "A_dft_seq_re": _A_in["dft_seq_re"],
        "A_dft_seq_im": _A_in["dft_seq_im"],
        "A_dft_hid_re": _A_in["dft_hid_re"],
        "A_dft_hid_im": _A_in["dft_hid_im"],
        "B_x": _B_in["x"],
        "B_w_gate": _B_in["w_gate"],
        "B_w_up": _B_in["w_up"],
        "B_w_down": _B_in["w_down"],
    }

def reference(A_x, A_dft_seq_re, A_dft_seq_im, A_dft_hid_re, A_dft_hid_im, B_x, B_w_gate, B_w_up, B_w_down):
    def _A_ref(x, dft_seq_re, dft_seq_im, dft_hid_re, dft_hid_im):
        a = torch.einsum("bsd,ed->bse", x, dft_hid_re)
        b = torch.einsum("bsd,ed->bse", x, dft_hid_im)
        y = torch.einsum("ts,bse->bte", dft_seq_re, a) - torch.einsum("ts,bse->bte", dft_seq_im, b)
        return y

    def _B_ref(x, w_gate, w_up, w_down):
        g = _silu(x @ w_gate)
        u = x @ w_up
        return (g * u) @ w_down

    x = A_x
    h = x + _A_ref(_layernorm(x, axis=-1), A_dft_seq_re, A_dft_seq_im, A_dft_hid_re, A_dft_hid_im)
    h2 = h + _B_ref(_layernorm(h, axis=-1), B_w_gate, B_w_up, B_w_down)
    return h2
```

```asm
; @launch grid=(256,1,1) block=(512,1,1) lds=163840
.amdgcn_target "amdgcn-amd-amdhsa--gfx950"
.text
.globl sequential_preLN__spectral_fnet__swiglu_ffn__prompt_kernel
.p2align 8
.type sequential_preLN__spectral_fnet__swiglu_ffn__prompt_kernel,@function
sequential_preLN__spectral_fnet__swiglu_ffn__prompt_kernel:
    s_cmp_ge_u32 s2, 0x100
    s_cbranch_scc1 L_exit
    s_load_dwordx2 s[4:5], s[0:1], 0
    s_load_dwordx8 s[36:43], s[0:1], 48
    s_load_dwordx4 s[44:47], s[0:1], 80
    v_lshrrev_b32 v17, 6, v0
    v_and_b32 v1, 63, v0
    v_readfirstlane_b32 s48, v17
    v_and_b32 v18, 15, v0
    v_lshrrev_b32 v19, 4, v1
    s_and_b32 s49, s2, 7
    s_lshr_b32 s50, s2, 5
    s_bfe_u32 s59, s2, 0x20003
    s_lshl_b32 s51, s49, 2
    s_add_u32 s51, s51, s59
    s_getpc_b64 s[6:7]
L_pc:
    s_lshr_b32 s60, s2, 3
    s_lshl_b32 s60, s60, 10
    v_lshl_add_u32 v23, v17, 7, s60
    v_min_u32 v23, L_end-L_pc-4, v23
    s_mov_b64 exec, 1
    global_load_dword v10, v23, s[6:7]
    s_mov_b64 exec, -1
    s_cmp_lt_u32 s48, 4
    s_cbranch_scc1 L_compute
    s_sub_u32 s48, s48, 4
    v_mov_b32 v28, 0
    v_lshlrev_b32 v22, 2, v18
    v_add_u32 v22, 0x27000, v22
    ds_write_b32 v22, v28
    v_mov_b32 v252, -1
    v_mov_b32 v253, -1
    v_mov_b32 v254, -1
    v_mov_b32 v255, -1
    v_lshrrev_b32 v17, 3, v1
    v_lshlrev_b32 v17, 15, v17
    v_and_b32 v22, 7, v1
    v_lshl_add_u32 v15, v22, 7, v17
    v_lshl_add_u32 v17, v22, 4, v17
    v_add_u32 v12, 0x40000, v17
    s_lshl_b32 s65, s48, 19
    s_lshl_b32 s59, s51, 10
    s_add_u32 s65, s65, s59
    s_lshl_b32 s59, s50, 16
    s_add_u32 s58, s65, s59
    s_lshl_b32 s59, s50, 7
    s_add_u32 s65, s65, s59
    s_lshl_b32 s74, s51, 8
    s_lshl_b32 s59, s48, 6
    s_add_u32 s74, s74, s59
    s_add_u32 s74, s74, 0x360000
    s_cmp_eq_u32 s50, 2
    s_cselect_b32 s32, s74, 0x1000000
    v_lshlrev_b32 v35, 2, v18
    s_waitcnt lgkmcnt(0)
    s_waitcnt lgkmcnt(0)
    s_mov_b32 s8, s4
    s_waitcnt lgkmcnt(0)
    s_and_b32 s9, s5, 0xffff
    s_mov_b32 s10, 0x200000
    s_mov_b32 s11, 0x20000
    s_mov_b64 exec, 0xffff
    buffer_load_dword v11, v15, s[8:11], s58 offen
    s_mov_b64 exec, -1
    s_waitcnt lgkmcnt(0)
    s_mov_b32 s28, s46
    s_waitcnt lgkmcnt(0)
    s_and_b32 s29, s47, 0xffff
    s_mov_b32 s30, 0x1000000
    s_mov_b32 s31, 0x20000
    s_waitcnt lgkmcnt(0)
    s_add_u32 s34, s46, 0x260000
    s_waitcnt lgkmcnt(0)
    s_addc_u32 s35, s47, 0
    s_load_dword s33, s[34:35], 0
    s_branch L_helper
L_compute:
    s_setprio 2
    v_bfe_u32 v22, v1, 2, 2
    v_lshlrev_b32 v17, 15, v22
    v_lshl_add_u32 v17, v19, 6, v17
    v_and_b32 v22, 3, v1
    v_lshl_add_u32 v17, v22, 4, v17
    s_lshl_b32 s58, s48, 19
    s_lshl_b32 s59, s51, 10
    s_add_u32 s58, s58, s59
    s_lshl_b32 s62, s50, 4
    v_add_u32 v32, s62, v18
    v_cmp_eq_u32 s[86:87], 0, v32
    v_mov_b32 v33, 0x80
    s_nop 0
    v_cndmask_b32 v32, v32, v33, s[86:87]
    v_cvt_f32_u32 v32, v32
    v_cvt_f32_u32 v33, v19
    v_mul_f32 v64, 0xbb000000, v32
    v_mul_f32 v65, 0x42000000, v33
    v_mul_f32 v65, v65, v64
    v_fmamk_f32 v36, v64, 0x00000000, v65
    v_fmamk_f32 v37, v64, 0x3f800000, v65
    v_fmamk_f32 v42, v64, 0x40000000, v65
    v_fmamk_f32 v43, v64, 0x40400000, v65
    v_fmamk_f32 v48, v64, 0x40800000, v65
    v_fmamk_f32 v49, v64, 0x40a00000, v65
    v_cos_f32 v38, v36
    v_sin_f32 v40, v36
    v_cos_f32 v39, v37
    v_sin_f32 v41, v37
    v_cos_f32 v44, v42
    v_sin_f32 v46, v42
    v_cos_f32 v45, v43
    v_sin_f32 v47, v43
    v_cos_f32 v50, v48
    v_sin_f32 v52, v48
    v_and_b32 v32, 1, v18
    v_mul_u32_u24 v71, 0x8000, v32
    v_cvt_pk_bf16_f32 v128, v38, v39
    v_cvt_pk_bf16_f32 v144, v40, v41
    v_cvt_pk_bf16_f32 v129, v44, v45
    v_cvt_pk_bf16_f32 v145, v46, v47
    v_cndmask_b32 v66, -1, 0, s[86:87]
    v_cos_f32 v51, v49
    v_mov_b32 v34, 0x80000000
    v_sin_f32 v53, v49
    v_mov_b32 v35, 0xbf803f80
    v_cvt_pk_bf16_f32 v130, v50, v51
    v_cndmask_b32 v67, v34, v35, s[86:87]
    v_cvt_pk_bf16_f32 v146, v52, v53
    v_and_b32 v68, 0x8000, v66
    v_lshl_or_b32 v71, v71, 16, v71
    v_fmamk_f32 v54, v64, 0x40c00000, v65
    v_fmamk_f32 v55, v64, 0x40e00000, v65
    v_cos_f32 v56, v54
    v_sin_f32 v58, v54
    v_cos_f32 v57, v55
    v_sin_f32 v59, v55
    v_bitop3_b32 v160, v128, v66, v67 bitop3:0x6a
    v_cvt_pk_bf16_f32 v131, v56, v57
    v_bitop3_b32 v176, v144, v66, v68 bitop3:0x6a
    v_cvt_pk_bf16_f32 v147, v58, v59
    v_bitop3_b32 v161, v129, v66, v67 bitop3:0x6a
    v_bitop3_b32 v177, v145, v66, v68 bitop3:0x6a
    v_bitop3_b32 v162, v130, v66, v67 bitop3:0x6a
    v_bitop3_b32 v178, v146, v66, v68 bitop3:0x6a
    v_xor_b32 v136, v71, v128
    v_bitop3_b32 v163, v131, v66, v67 bitop3:0x6a
    v_xor_b32 v152, v71, v144
    v_bitop3_b32 v179, v147, v66, v68 bitop3:0x6a
    v_xor_b32 v168, v71, v160
    v_xor_b32 v184, v71, v176
    v_fmamk_f32 v36, v64, 0x43000000, v65
    v_fmamk_f32 v37, v64, 0x43010000, v65
    v_cos_f32 v38, v36
    v_sin_f32 v40, v36
    v_cos_f32 v39, v37
    s_waitcnt lgkmcnt(0)
    s_mov_b32 s8, s4
    s_and_b32 s9, s5, 0xffff
    s_mov_b32 s10, 0x200000
    s_mov_b32 s11, 0x20000
    s_add_u32 s34, s46, 0x260000
    s_addc_u32 s35, s47, 0
    s_load_dword s33, s[34:35], 0
    s_add_u32 s60, s58, 0x0
    buffer_load_dwordx4 v[192:195], v17, s[8:11], s60 offen offset:0
    buffer_load_dwordx4 v[196:199], v17, s[8:11], s60 offen offset:256
    v_sin_f32 v41, v37
    v_cvt_pk_bf16_f32 v132, v38, v39
    v_cvt_pk_bf16_f32 v148, v40, v41
    v_xor_b32 v137, v71, v129
    v_bitop3_b32 v164, v132, v66, v67 bitop3:0x6a
    v_xor_b32 v153, v71, v145
    v_bitop3_b32 v180, v148, v66, v68 bitop3:0x6a
    v_xor_b32 v169, v71, v161
    v_xor_b32 v185, v71, v177
    buffer_load_dwordx4 v[200:203], v17, s[8:11], s60 offen offset:512
    v_fmamk_f32 v42, v64, 0x43020000, v65
    v_fmamk_f32 v43, v64, 0x43030000, v65
    v_cos_f32 v44, v42
    v_sin_f32 v46, v42
    v_cos_f32 v45, v43
    v_sin_f32 v47, v43
    buffer_load_dwordx4 v[204:207], v17, s[8:11], s60 offen offset:768
    v_cvt_pk_bf16_f32 v133, v44, v45
    v_cvt_pk_bf16_f32 v149, v46, v47
    v_xor_b32 v138, v71, v130
    v_bitop3_b32 v165, v133, v66, v67 bitop3:0x6a
    v_xor_b32 v154, v71, v146
    v_bitop3_b32 v181, v149, v66, v68 bitop3:0x6a
    v_xor_b32 v170, v71, v162
    v_xor_b32 v186, v71, v178
    v_fmamk_f32 v48, v64, 0x43040000, v65
    v_fmamk_f32 v49, v64, 0x43050000, v65
    s_add_u32 s60, s58, 0x20000
    buffer_load_dwordx4 v[208:211], v17, s[8:11], s60 offen offset:0
    v_cos_f32 v50, v48
    v_sin_f32 v52, v48
    v_cos_f32 v51, v49
    v_sin_f32 v53, v49
    v_cvt_pk_bf16_f32 v134, v50, v51
    v_cvt_pk_bf16_f32 v150, v52, v53
    buffer_load_dwordx4 v[212:215], v17, s[8:11], s60 offen offset:256
    v_xor_b32 v139, v71, v131
    v_bitop3_b32 v166, v134, v66, v67 bitop3:0x6a
    v_xor_b32 v155, v71, v147
    v_bitop3_b32 v182, v150, v66, v68 bitop3:0x6a
    v_xor_b32 v171, v71, v163
    v_xor_b32 v187, v71, v179
    v_fmamk_f32 v54, v64, 0x43060000, v65
    v_fmamk_f32 v55, v64, 0x43070000, v65
    v_cos_f32 v56, v54
    buffer_load_dwordx4 v[216:219], v17, s[8:11], s60 offen offset:512
    v_sin_f32 v58, v54
    v_cos_f32 v57, v55
    v_sin_f32 v59, v55
    v_cvt_pk_bf16_f32 v135, v56, v57
    v_cvt_pk_bf16_f32 v151, v58, v59
    v_xor_b32 v140, v71, v132
    v_bitop3_b32 v167, v135, v66, v67 bitop3:0x6a
    buffer_load_dwordx4 v[220:223], v17, s[8:11], s60 offen offset:768
    v_xor_b32 v156, v71, v148
    v_bitop3_b32 v183, v151, v66, v68 bitop3:0x6a
    v_xor_b32 v172, v71, v164
    v_xor_b32 v188, v71, v180
    v_cmp_eq_u32 vcc, 0, v19
    v_mov_b32 v33, 0x3f80
    s_nop 0
    v_cndmask_b32 v124, 0, v33, vcc
    v_mov_b32 v120, 0x3f803f80
    v_xor_b32 v141, v71, v133
    v_mul_f32 v36, 0x41000000, v64
    s_add_u32 s60, s58, 0x40000
    buffer_load_dwordx4 v[224:227], v17, s[8:11], s60 offen offset:0
    v_xor_b32 v157, v71, v149
    v_cos_f32 v22, v36
    v_xor_b32 v173, v71, v165
    v_sin_f32 v25, v36
    v_xor_b32 v189, v71, v181
    v_lshlrev_b32 v32, 2, v19
    v_sub_u32 v32, v18, v32
    v_cmp_eq_u32 vcc, 0, v32
    buffer_load_dwordx4 v[228:231], v17, s[8:11], s60 offen offset:256
    s_nop 0
    v_cndmask_b32 v28, 0, 1.0, vcc
    v_cmp_eq_u32 vcc, 1, v32
    v_mul_f32 v42, 0x41800000, v64
    v_mul_f32 v48, 0x41c00000, v64
    v_cos_f32 v23, v42
    v_sin_f32 v26, v42
    v_cos_f32 v24, v48
    buffer_load_dwordx4 v[232:235], v17, s[8:11], s60 offen offset:512
    v_sin_f32 v27, v48
    v_xor_b32 v142, v71, v134
    v_cndmask_b32 v29, 0, 1.0, vcc
    v_xor_b32 v158, v71, v150
    v_cmp_eq_u32 vcc, 2, v32
    v_xor_b32 v174, v71, v166
    s_nop 0
    v_cndmask_b32 v30, 0, 1.0, vcc
    v_xor_b32 v190, v71, v182
    v_cmp_eq_u32 vcc, 3, v32
    buffer_load_dwordx4 v[236:239], v17, s[8:11], s60 offen offset:768
    v_xor_b32 v143, v71, v135
    v_xor_b32 v159, v71, v151
    v_xor_b32 v175, v71, v167
    v_xor_b32 v191, v71, v183
    v_mov_b32 v121, v120
    v_mov_b32 v122, v120
    v_mov_b32 v123, v120
    v_mov_b32 v125, 0
    v_mov_b32 v126, 0
    v_mov_b32 v127, 0
    v_cndmask_b32 v31, 0, 1.0, vcc
    s_add_u32 s60, s58, 0x60000
    buffer_load_dwordx4 v[240:243], v17, s[8:11], s60 offen offset:0
    s_waitcnt vmcnt(12)
    v_mfma_f32_16x16x32_bf16 v[64:67], v[192:195], v[120:123], 0
    s_and_b32 s53, s49, 3
    s_lshl_b32 s53, s53, 2
    s_lshr_b32 s59, s2, 6
    v_mfma_f32_16x16x32_bf16 v[68:71], v[192:195], v[192:195], 0
    s_add_u32 s53, s53, s59
    s_and_b32 s56, s53, 3
    s_waitcnt vmcnt(11)
    v_mfma_f32_16x16x32_bf16 v[72:75], v[192:195], v[128:131], 0
    s_bfe_u32 s59, s2, 0x10005
    v_mov_b32 v60, 0x3727c5ac
    s_lshl_b32 s56, s56, 2
    v_mfma_f32_16x16x32_bf16 v[76:79], v[192:195], v[144:147], 0
    s_lshl_b32 s59, s59, 5
    buffer_load_dwordx4 v[244:247], v17, s[8:11], s60 offen offset:256
    s_add_u32 s56, s56, s48
    v_mfma_f32_16x16x32_bf16 v[80:83], v[192:195], v[160:163], 0
    s_add_u32 s55, s51, s59
    v_and_b32 v20, 31, v1
    v_lshlrev_b32 v14, 2, v20
    v_mfma_f32_16x16x32_bf16 v[84:87], v[192:195], v[176:179], 0
    s_cmp_eq_u32 s56, 0
    s_cselect_b32 s59, 0, 0x1000000
    v_add_u32 v16, s59, v14
    v_mfma_f32_16x16x32_bf16 v[88:91], v[192:195], v[124:127], 0
    s_lshl_b32 s65, s48, 19
    s_lshl_b32 s59, s51, 10
    s_add_u32 s65, s65, s59
    v_mfma_f32_16x16x32_bf16 v[64:67], v[196:199], v[120:123], v[64:67]
    s_lshl_b32 s59, s50, 7
    buffer_load_dwordx4 v[248:251], v17, s[8:11], s60 offen offset:512
    s_add_u32 s65, s65, s59
    v_mfma_f32_16x16x32_bf16 v[68:71], v[196:199], v[196:199], v[68:71]
    s_waitcnt vmcnt(12)
    s_lshl_b32 s59, s55, 4
    s_and_b32 s52, s55, 0x33
    v_mfma_f32_16x16x32_bf16 v[72:75], v[196:199], v[132:135], v[72:75]
    s_lshl_b32 s61, s48, 2
    s_add_u32 s59, s59, s56
    s_add_u32 s61, s61, s52
    v_mfma_f32_16x16x32_bf16 v[76:79], v[196:199], v[148:151], v[76:79]
    s_lshl_b32 s66, s59, 11
    s_mul_i32 s64, s61, 98304
    s_lshl_b32 s59, s53, 11
    v_mfma_f32_16x16x32_bf16 v[80:83], v[196:199], v[164:167], v[80:83]
    s_mov_b32 s36, 0
    buffer_load_dwordx4 v[252:255], v17, s[8:11], s60 offen offset:768
    s_barrier
    v_mfma_f32_16x16x32_bf16 v[84:87], v[196:199], v[180:183], v[84:87]
    s_add_u32 s64, s64, s59
    s_mul_i32 s59, s36, 12
    s_mov_b32 s38, 0xa9765320
    v_mfma_f32_16x16x32_bf16 v[64:67], v[200:203], v[120:123], v[64:67]
    s_mov_b32 s39, 0xfdc
    s_lshr_b64 s[86:87], s[38:39], s59
    s_sub_u32 s59, 44, s59
    v_mfma_f32_16x16x32_bf16 v[68:71], v[200:203], v[200:203], v[68:71]
    s_waitcnt vmcnt(12)
    s_lshl_b64 s[38:39], s[38:39], s59
    s_mul_i32 s57, s53, 43
    v_mfma_f32_16x16x32_bf16 v[72:75], v[200:203], v[136:139], v[72:75]
    s_mul_i32 s59, s53, 43
    s_add_u32 s57, s57, 8
    s_add_u32 s59, s59, 51
    v_mfma_f32_16x16x32_bf16 v[76:79], v[200:203], v[152:155], v[76:79]
    s_lshr_b32 s57, s57, 4
    s_add_u32 s64, s64, 0x600000
    s_lshr_b32 s59, s59, 4
    v_mfma_f32_16x16x32_bf16 v[80:83], v[200:203], v[168:171], v[80:83]
    s_sub_u32 s59, s59, s57
    s_add_u32 s3, s64, 0x10000
    s_lshl_b32 s82, s61, 15
    v_mfma_f32_16x16x32_bf16 v[84:87], v[200:203], v[184:187], v[84:87]
    s_mul_i32 s6, s61, 2176
    s_lshr_b32 s74, s48, 1
    s_and_b32 s61, s48, 1
    v_mfma_f32_16x16x32_bf16 v[64:67], v[204:207], v[120:123], v[64:67]
    s_cmp_eq_u32 s59, 3
    s_cselect_b32 s3, s3, 0x1000000
    s_cselect_b32 s79, 0, 0x400000
    v_mfma_f32_16x16x32_bf16 v[68:71], v[204:207], v[204:207], v[68:71]
    s_lshl_b32 s59, s74, 12
    s_waitcnt vmcnt(11)
    s_lshl_b32 s61, s61, 3
    v_mfma_f32_16x16x32_bf16 v[72:75], v[204:207], v[140:143], v[72:75]
    s_add_u32 s59, s59, s61
    v_lshlrev_b32 v2, 4, v1
    v_add_f32 v53, v64, v65
    v_mfma_f32_16x16x32_bf16 v[76:79], v[204:207], v[156:159], v[76:79]
    s_add_u32 s59, s59, 0x25000
    v_add_f32 v54, v66, v67
    v_add_f32 v53, v53, v54
    v_mfma_f32_16x16x32_bf16 v[80:83], v[204:207], v[172:175], v[80:83]
    s_lshl_b32 s69, s51, 8
    v_mul_f32 v52, v28, v68
    v_mul_f32 v48, 0xbb000000, v53
    v_mfma_f32_16x16x32_bf16 v[84:87], v[204:207], v[188:191], v[84:87]
    s_mov_b32 s28, s46
    v_fmac_f32 v52, v29, v69
    v_add_f32 v55, v48, v88
    v_mfma_f32_16x16x32_bf16 v[92:95], v[208:211], v[120:123], 0
    s_and_b32 s29, s47, 0xffff
    v_fmac_f32 v52, v30, v70
    v_sub_f32 v32, v72, v55
    v_mfma_f32_16x16x32_bf16 v[96:99], v[208:211], v[208:211], 0
    s_mov_b32 s30, 0x1000000
    v_fma_f32 v36, v22, v77, v76
    s_waitcnt vmcnt(10)
    v_mfma_f32_16x16x32_bf16 v[100:103], v[208:211], v[128:131], 0
    s_mov_b32 s31, 0x20000
    v_fmac_f32 v52, v31, v71
    v_fmac_f32 v32, v22, v73
    v_mfma_f32_16x16x32_bf16 v[104:107], v[208:211], v[144:147], 0
    s_mul_i32 s67, s55, 17
    v_fmac_f32 v36, v25, v73
    v_fma_f32 v32, -v25, v77, v32
    v_mfma_f32_16x16x32_bf16 v[108:111], v[208:211], v[160:163], 0
    s_add_u32 s67, s67, s56
    v_fmac_f32 v36, v23, v78
    v_fmac_f32 v32, v23, v74
    v_mfma_f32_16x16x32_bf16 v[112:115], v[208:211], v[176:179], 0
    s_lshl_b32 s5, s52, 11
    v_fmac_f32 v36, v26, v74
    v_fma_f32 v32, -v26, v78, v32
    v_mfma_f32_16x16x32_bf16 v[116:119], v[208:211], v[124:127], 0
    s_lshl_b32 s67, s67, 7
    v_fmac_f32 v36, v24, v79
    v_fmac_f32 v32, v24, v75
    v_mfma_f32_16x16x32_bf16 v[92:95], v[212:215], v[120:123], v[92:95]
    s_add_u32 s5, s5, 0x261000
    v_fmac_f32 v36, v27, v75
    v_sub_f32 v40, v80, v55
    v_mfma_f32_16x16x32_bf16 v[96:99], v[212:215], v[212:215], v[96:99]
    s_waitcnt vmcnt(9)
    v_fma_f32 v44, v22, v85, v84
    v_fma_f32 v32, -v27, v79, v32
    v_mfma_f32_16x16x32_bf16 v[100:103], v[212:215], v[132:135], v[100:103]
    s_lshl_b32 s4, s53, 7
    v_fmac_f32 v40, v22, v81
    v_fma_f32 v44, -v25, v81, v44
    v_mfma_f32_16x16x32_bf16 v[104:107], v[212:215], v[148:151], v[104:107]
    s_mov_b32 s24, s42
    v_fmac_f32 v40, v25, v85
    v_fmac_f32 v44, v23, v86
    v_mfma_f32_16x16x32_bf16 v[108:111], v[212:215], v[164:167], v[108:111]
    s_and_b32 s25, s43, 0xffff
    v_fmac_f32 v40, v23, v82
    v_fma_f32 v44, -v26, v82, v44
    v_mfma_f32_16x16x32_bf16 v[112:115], v[212:215], v[180:183], v[112:115]
    s_mov_b32 s26, 0x200000
    v_fmac_f32 v40, v26, v86
    v_fmac_f32 v44, v24, v87
    v_mfma_f32_16x16x32_bf16 v[92:95], v[216:219], v[120:123], v[92:95]
    s_mov_b32 s27, 0x20000
    v_fmac_f32 v40, v24, v83
    v_fma_f32 v44, -v27, v83, v44
    v_mfma_f32_16x16x32_bf16 v[96:99], v[216:219], v[216:219], v[96:99]
    s_waitcnt vmcnt(8)
    v_fmac_f32 v40, v27, v87
    v_add_f32_dpp v52, v52, v52 row_ror:8 row_mask:0xf bank_mask:0xf
    v_mfma_f32_16x16x32_bf16 v[100:103], v[216:219], v[136:139], v[100:103]
    s_and_b32 s73, s53, 7
    v_add_u32 v13, s59, v2
    v_add_f32_dpp v52, v52, v52 row_ror:4 row_mask:0xf bank_mask:0xf
    v_mfma_f32_16x16x32_bf16 v[104:107], v[216:219], v[152:155], v[104:107]
    s_lshl_b32 s59, s74, 10
    s_add_u32 s59, s59, s61
    v_add_f32_dpp v52, v52, v52 row_ror:2 row_mask:0xf bank_mask:0xf
    v_mfma_f32_16x16x32_bf16 v[108:111], v[216:219], v[168:171], v[108:111]
    s_add_u32 s59, s59, 0x27400
    v_add_u32 v0, s59, v2
    v_add_f32_dpp v52, v52, v52 row_ror:1 row_mask:0xf bank_mask:0xf
    v_mfma_f32_16x16x32_bf16 v[112:115], v[216:219], v[184:187], v[112:115]
    s_lshl_b32 s59, s48, 6
    s_add_u32 s69, s69, s59
    v_fmamk_f32 v52, v52, 0x3b000000, v60
    v_mfma_f32_16x16x32_bf16 v[92:95], v[220:223], v[120:123], v[92:95]
    s_mul_i32 s59, s48, 6144
    v_fma_f32 v52, -v48, v48, v52
    s_add_u32 s59, s59, 0x1d000
    v_mfma_f32_16x16x32_bf16 v[96:99], v[220:223], v[220:223], v[96:99]
    s_add_u32 s69, s69, 0x360000
    s_waitcnt vmcnt(7)
    v_add_u32 v4, s59, v2
    v_mfma_f32_16x16x32_bf16 v[100:103], v[220:223], v[140:143], v[100:103]
    s_cmp_eq_u32 s50, 2
    s_cselect_b32 s69, s69, 0x1000000
    v_add_f32 v57, v92, v93
    v_mfma_f32_16x16x32_bf16 v[104:107], v[220:223], v[156:159], v[104:107]
    s_add_u32 s67, s67, 0x290000
    v_add_f32 v58, v94, v95
    v_mul_f32 v56, v28, v96
    v_mfma_f32_16x16x32_bf16 v[108:111], v[220:223], v[172:175], v[108:111]
    s_add_u32 s4, s4, s5
    v_fmac_f32 v56, v29, v97
    v_fmac_f32 v56, v30, v98
    v_mfma_f32_16x16x32_bf16 v[112:115], v[220:223], v[188:191], v[112:115]
    s_add_u32 s66, s66, 0x400000
    v_fmac_f32 v56, v31, v99
    v_add_f32 v57, v57, v58
    v_mfma_f32_16x16x32_bf16 v[64:67], v[224:227], v[120:123], 0
    s_add_u32 s37, s64, 0x8000
    v_mul_f32 v49, 0xbb000000, v57
    v_add_f32 v59, v49, v116
    v_mfma_f32_16x16x32_bf16 v[68:71], v[224:227], v[224:227], 0
    s_bfe_u32 s41, s2, 0x30003
    v_sub_f32 v33, v100, v59
    s_waitcnt vmcnt(6)
    v_mfma_f32_16x16x32_bf16 v[72:75], v[224:227], v[128:131], 0
    s_or_b64 s[38:39], s[38:39], s[86:87]
    v_fma_f32 v37, v22, v105, v104
    v_fmac_f32 v33, v22, v101
    v_mfma_f32_16x16x32_bf16 v[76:79], v[224:227], v[144:147], 0
    s_lshr_b32 s54, s53, 3
    v_fmac_f32 v37, v25, v101
    v_fma_f32 v33, -v25, v105, v33
    v_mfma_f32_16x16x32_bf16 v[80:83], v[224:227], v[160:163], 0
    s_add_u32 s82, s82, 0x400000
    v_fmac_f32 v37, v23, v106
    v_fmac_f32 v33, v23, v102
    v_mfma_f32_16x16x32_bf16 v[84:87], v[224:227], v[176:179], 0
    s_add_u32 s6, s6, 0x290080
    v_fmac_f32 v37, v26, v102
    v_fma_f32 v33, -v26, v106, v33
    v_mfma_f32_16x16x32_bf16 v[88:91], v[224:227], v[124:127], 0
    v_fmac_f32 v37, v24, v107
    v_fmac_f32 v33, v24, v103
    v_mfma_f32_16x16x32_bf16 v[64:67], v[228:231], v[120:123], v[64:67]
    v_fmac_f32 v37, v27, v103
    v_fma_f32 v33, -v27, v107, v33
    v_mfma_f32_16x16x32_bf16 v[68:71], v[228:231], v[228:231], v[68:71]
    s_waitcnt vmcnt(5)
    v_sub_f32 v41, v108, v59
    v_fma_f32 v45, v22, v113, v112
    v_mfma_f32_16x16x32_bf16 v[72:75], v[228:231], v[132:135], v[72:75]
    v_fmac_f32 v41, v22, v109
    v_fma_f32 v45, -v25, v109, v45
    v_mfma_f32_16x16x32_bf16 v[76:79], v[228:231], v[148:151], v[76:79]
    v_fmac_f32 v41, v25, v113
    v_fmac_f32 v45, v23, v114
    v_mfma_f32_16x16x32_bf16 v[80:83], v[228:231], v[164:167], v[80:83]
    v_fmac_f32 v41, v23, v110
    v_fma_f32 v45, -v26, v110, v45
    v_mfma_f32_16x16x32_bf16 v[84:87], v[228:231], v[180:183], v[84:87]
    v_fmac_f32 v41, v26, v114
    v_fmac_f32 v45, v24, v115
    v_mfma_f32_16x16x32_bf16 v[64:67], v[232:235], v[120:123], v[64:67]
    v_fmac_f32 v41, v24, v111
    v_fma_f32 v45, -v27, v111, v45
    v_mfma_f32_16x16x32_bf16 v[68:71], v[232:235], v[232:235], v[68:71]
    s_waitcnt vmcnt(4)
    v_fmac_f32 v41, v27, v115
    v_add_f32_dpp v56, v56, v56 row_ror:8 row_mask:0xf bank_mask:0xf
    v_mfma_f32_16x16x32_bf16 v[72:75], v[232:235], v[136:139], v[72:75]
    v_rsq_f32 v52, v52
    v_mfma_f32_16x16x32_bf16 v[76:79], v[232:235], v[152:155], v[76:79]
    v_add_f32_dpp v56, v56, v56 row_ror:4 row_mask:0xf bank_mask:0xf
    v_mul_f32 v32, v32, v52
    v_mfma_f32_16x16x32_bf16 v[80:83], v[232:235], v[168:171], v[80:83]
    v_add_f32_dpp v56, v56, v56 row_ror:2 row_mask:0xf bank_mask:0xf
    v_mul_f32 v36, v36, v52
    v_mfma_f32_16x16x32_bf16 v[84:87], v[232:235], v[184:187], v[84:87]
    v_add_f32_dpp v56, v56, v56 row_ror:1 row_mask:0xf bank_mask:0xf
    v_mul_f32 v61, v55, v52
    v_mfma_f32_16x16x32_bf16 v[64:67], v[236:239], v[120:123], v[64:67]
    v_fmamk_f32 v56, v56, 0x3b000000, v60
    v_fma_f32 v56, -v49, v49, v56
    v_mfma_f32_16x16x32_bf16 v[68:71], v[236:239], v[236:239], v[68:71]
    v_rsq_f32 v56, v56
    v_mfma_f32_16x16x32_bf16 v[72:75], v[236:239], v[140:143], v[72:75]
    s_waitcnt vmcnt(3)
    s_waitcnt vmcnt(2)
    s_waitcnt vmcnt(1)
    v_mfma_f32_16x16x32_bf16 v[76:79], v[236:239], v[156:159], v[76:79]
    s_waitcnt vmcnt(0)
    v_mul_f32 v40, v40, v52
    v_mul_f32 v44, v44, v52
    v_mfma_f32_16x16x32_bf16 v[80:83], v[236:239], v[172:175], v[80:83]
    v_mul_f32 v33, v33, v56
    v_mul_f32 v37, v37, v56
    v_mfma_f32_16x16x32_bf16 v[84:87], v[236:239], v[188:191], v[84:87]
    v_mul_f32 v11, v59, v56
    v_mul_f32 v41, v41, v56
    v_mfma_f32_16x16x32_bf16 v[92:95], v[240:243], v[120:123], 0
    v_mul_f32 v45, v45, v56
    v_mul_f32 v52, v28, v68
    v_mfma_f32_16x16x32_bf16 v[96:99], v[240:243], v[240:243], 0
    v_fmac_f32 v52, v29, v69
    v_fmac_f32 v52, v30, v70
    v_mfma_f32_16x16x32_bf16 v[116:119], v[240:243], v[124:127], 0
    v_fmac_f32 v52, v31, v71
    s_nop 1
    v_add_f32_dpp v52, v52, v52 row_ror:8 row_mask:0xf bank_mask:0xf
    v_mfma_f32_16x16x32_bf16 v[92:95], v[244:247], v[120:123], v[92:95]
    v_add_f32 v53, v64, v65
    v_add_f32_dpp v52, v52, v52 row_ror:4 row_mask:0xf bank_mask:0xf
    v_mfma_f32_16x16x32_bf16 v[96:99], v[244:247], v[244:247], v[96:99]
    v_add_f32 v54, v66, v67
    v_add_f32_dpp v52, v52, v52 row_ror:2 row_mask:0xf bank_mask:0xf
    v_mfma_f32_16x16x32_bf16 v[92:95], v[248:251], v[120:123], v[92:95]
    v_add_f32 v53, v53, v54
    v_mul_f32 v50, 0xbb000000, v53
    v_mfma_f32_16x16x32_bf16 v[96:99], v[248:251], v[248:251], v[96:99]
    v_add_f32_dpp v52, v52, v52 row_ror:1 row_mask:0xf bank_mask:0xf
    v_add_f32 v55, v50, v88
    v_mfma_f32_16x16x32_bf16 v[92:95], v[252:255], v[120:123], v[92:95]
    v_sub_f32 v34, v72, v55
    v_sub_f32 v42, v80, v55
    v_mfma_f32_16x16x32_bf16 v[96:99], v[252:255], v[252:255], v[96:99]
    v_fmac_f32 v34, v22, v73
    v_fma_f32 v38, v22, v77, v76
    v_mfma_f32_16x16x32_bf16 v[100:103], v[240:243], v[128:131], 0
    ds_read_b128 v[128:131], v4 offset:0
    s_nop 0
    v_add_f32 v57, v92, v93
    v_mfma_f32_16x16x32_bf16 v[104:107], v[240:243], v[144:147], 0
    v_add_f32 v58, v94, v95
    v_mul_f32 v56, v28, v96
    v_mfma_f32_16x16x32_bf16 v[100:103], v[244:247], v[132:135], v[100:103]
    ds_read_b128 v[132:135], v4 offset:1024
    v_fmac_f32 v56, v29, v97
    v_mfma_f32_16x16x32_bf16 v[104:107], v[244:247], v[148:151], v[104:107]
    v_fmac_f32 v56, v30, v98
    v_fmac_f32 v56, v31, v99
    v_mfma_f32_16x16x32_bf16 v[100:103], v[248:251], v[136:139], v[100:103]
    ds_read_b128 v[136:139], v4 offset:2048
    v_add_f32_dpp v56, v56, v56 row_ror:8 row_mask:0xf bank_mask:0xf
    v_mfma_f32_16x16x32_bf16 v[104:107], v[248:251], v[152:155], v[104:107]
    v_add_f32 v57, v57, v58
    v_add_f32_dpp v56, v56, v56 row_ror:4 row_mask:0xf bank_mask:0xf
    v_mfma_f32_16x16x32_bf16 v[100:103], v[252:255], v[140:143], v[100:103]
    ds_read_b128 v[140:143], v4 offset:3072
    ds_read_b128 v[144:147], v4 offset:4096
    v_mfma_f32_16x16x32_bf16 v[104:107], v[252:255], v[156:159], v[104:107]
    ds_read_b128 v[148:151], v4 offset:5120
    v_add_f32_dpp v56, v56, v56 row_ror:2 row_mask:0xf bank_mask:0xf
    v_mfma_f32_16x16x32_bf16 v[108:111], v[240:243], v[160:163], 0
    v_mul_f32 v51, 0xbb000000, v57
    v_add_f32_dpp v56, v56, v56 row_ror:1 row_mask:0xf bank_mask:0xf
    v_mfma_f32_16x16x32_bf16 v[112:115], v[240:243], v[176:179], 0
    v_add_f32 v59, v51, v116
    v_sub_f32 v35, v100, v59
    v_mfma_f32_16x16x32_bf16 v[108:111], v[244:247], v[164:167], v[108:111]
    v_fmac_f32 v35, v22, v101
    v_fma_f32 v39, v22, v105, v104
    v_mfma_f32_16x16x32_bf16 v[112:115], v[244:247], v[180:183], v[112:115]
    v_fmac_f32 v42, v22, v81
    v_fma_f32 v46, v22, v85, v84
    v_mfma_f32_16x16x32_bf16 v[108:111], v[248:251], v[168:171], v[108:111]
    v_fmamk_f32 v52, v52, 0x3b000000, v60
    v_fma_f32 v34, -v25, v77, v34
    v_mfma_f32_16x16x32_bf16 v[112:115], v[248:251], v[184:187], v[112:115]
    v_fmamk_f32 v56, v56, 0x3b000000, v60
    v_fma_f32 v35, -v25, v105, v35
    v_mfma_f32_16x16x32_bf16 v[108:111], v[252:255], v[172:175], v[108:111]
    v_fmac_f32 v38, v25, v73
    v_fmac_f32 v39, v25, v101
    v_mfma_f32_16x16x32_bf16 v[112:115], v[252:255], v[188:191], v[112:115]
    v_fmac_f32 v42, v25, v85
    v_fma_f32 v46, -v25, v81, v46
    v_fma_f32 v52, -v50, v50, v52
    v_fmac_f32 v34, v23, v74
    v_fma_f32 v56, -v51, v51, v56
    v_sub_f32 v43, v108, v59
    v_fmac_f32 v43, v22, v109
    v_fmac_f32 v35, v23, v102
    v_fmac_f32 v38, v23, v78
    v_fma_f32 v47, v22, v113, v112
    v_fmac_f32 v43, v25, v113
    v_fma_f32 v47, -v25, v109, v47
    v_fmac_f32 v39, v23, v106
    v_fmac_f32 v42, v23, v82
    v_fmac_f32 v43, v23, v110
    v_fmac_f32 v46, v23, v86
    v_fmac_f32 v47, v23, v114
    v_rsq_f32 v52, v52
    v_fma_f32 v34, -v26, v78, v34
    v_rsq_f32 v56, v56
    v_fma_f32 v35, -v26, v106, v35
    v_fmac_f32 v38, v26, v74
    v_fmac_f32 v39, v26, v102
    v_fmac_f32 v42, v26, v86
    v_fmac_f32 v43, v26, v114
    v_fma_f32 v46, -v26, v82, v46
    v_fma_f32 v47, -v26, v110, v47
    v_fmac_f32 v34, v24, v75
    v_fmac_f32 v35, v24, v103
    v_fmac_f32 v38, v24, v79
    v_fmac_f32 v39, v24, v107
    v_fmac_f32 v42, v24, v83
    v_fmac_f32 v43, v24, v111
    v_fmac_f32 v46, v24, v87
    v_fmac_f32 v47, v24, v115
    v_fma_f32 v34, -v27, v79, v34
    v_fma_f32 v35, -v27, v107, v35
    v_fmac_f32 v38, v27, v75
    v_fmac_f32 v39, v27, v103
    v_fmac_f32 v42, v27, v87
    v_fmac_f32 v43, v27, v115
    v_fma_f32 v46, -v27, v83, v46
    v_fma_f32 v47, -v27, v111, v47
    v_mul_f32 v34, v34, v52
    v_mul_f32 v35, v35, v56
    v_mul_f32 v38, v38, v52
    v_mul_f32 v39, v39, v56
    v_mul_f32 v42, v42, v52
    v_mul_f32 v43, v43, v56
    v_mul_f32 v46, v46, v52
    v_mul_f32 v47, v47, v56
    v_cvt_pk_bf16_f32 v32, v32, v33
    v_mul_f32 v15, v55, v52
    v_mul_f32 v17, v59, v56
    v_cvt_pk_bf16_f32 v33, v34, v35
    v_cvt_pk_bf16_f32 v36, v36, v37
    v_cvt_pk_bf16_f32 v37, v38, v39
    v_cvt_pk_bf16_f32 v40, v40, v41
    v_cvt_pk_bf16_f32 v41, v42, v43
    v_cvt_pk_bf16_f32 v44, v44, v45
    v_cvt_pk_bf16_f32 v45, v46, v47
    v_cvt_pk_bf16_f32 v60, -v61, -v11
    ds_write_b64 v13, v[32:33] offset:0
    ds_write_b64 v13, v[36:37] offset:1024
    ds_write_b64 v13, v[40:41] offset:2048
    ds_write_b64 v13, v[44:45] offset:3072
    v_cvt_pk_bf16_f32 v61, -v15, -v17
    ds_write_b64 v0, v[60:61]
    v_add_u32 v5, 0x25000, v2
    v_lshrrev_b32 v21, 5, v1
    v_add_u32 v9, 0x80, v14
    v_cmp_eq_u32 vcc, 0, v21
    s_nop 1
    v_cndmask_b32 v16, v16, v9, vcc
    v_lshrrev_b32 v9, 3, v1
    v_lshlrev_b32 v7, 15, v9
    v_and_b32 v9, 7, v1
    v_lshl_add_u32 v7, v9, 4, v7
    v_and_b32 v9, 7, v18
    v_lshl_add_u32 v63, v18, 7, s59
    v_xor_b32 v9, v9, v19
    v_lshl_add_u32 v63, v9, 4, v63
    s_waitcnt lgkmcnt(0)
    s_barrier
    ds_read_b128 v[64:67], v5 offset:0
    ds_read_b128 v[72:75], v5 offset:2048
    ds_read_b128 v[68:71], v5 offset:1024
    ds_read_b128 v[76:79], v5 offset:3072
    ds_read_b128 v[80:83], v5 offset:4096
    ds_read_b128 v[88:91], v5 offset:6144
    ds_read_b128 v[84:87], v5 offset:5120
    ds_read_b128 v[92:95], v5 offset:7168
    ds_read_b128 v[152:155], v5 offset:9216
    ds_read_b128 v[156:159], v5 offset:10240
    v_lshrrev_b32 v9, 3, v1
    v_lshlrev_b32 v9, 4, v9
    v_xor_b32 v9, v9, v2
    v_xor_b32 v10, 64, v63
    v_add_u32 v3, s59, v9
    s_lshl_b32 s59, s48, 2
    s_add_u32 s59, s59, 0x27010
    v_lshlrev_b32 v12, 11, v19
    v_bfe_u32 v9, v1, 3, 1
    v_mov_b32 v8, s59
    v_lshl_add_u32 v12, v9, 6, v12
    v_and_b32 v9, 3, v1
    s_lshl_b32 s59, s48, 9
    v_lshl_add_u32 v12, v9, 4, v12
    s_add_u32 s59, s59, 0x23000
    v_add_u32 v12, s59, v12
    s_waitcnt lgkmcnt(9)
    v_mfma_f32_16x16x32_bf16 v[96:99], v[64:67], v[128:131], 0
    s_lshl_b32 s59, s48, 6
    s_add_u32 s59, s59, 0x27100
    v_mov_b32 v6, 0x27000
    v_mfma_f32_16x16x32_bf16 v[100:103], v[64:67], v[132:135], 0
    v_lshl_add_u32 v62, v19, 2, s59
    s_waitcnt lgkmcnt(8)
    v_mfma_f32_16x16x32_bf16 v[104:107], v[72:75], v[128:131], 0
    v_mfma_f32_16x16x32_bf16 v[108:111], v[72:75], v[132:135], 0
    s_waitcnt lgkmcnt(7)
    v_mfma_f32_16x16x32_bf16 v[96:99], v[68:71], v[136:139], v[96:99]
    v_mfma_f32_16x16x32_bf16 v[100:103], v[68:71], v[128:131], v[100:103]
    s_waitcnt lgkmcnt(6)
    v_mfma_f32_16x16x32_bf16 v[104:107], v[76:79], v[136:139], v[104:107]
    v_mfma_f32_16x16x32_bf16 v[108:111], v[76:79], v[128:131], v[108:111]
    s_waitcnt lgkmcnt(5)
    v_mfma_f32_16x16x32_bf16 v[96:99], v[80:83], v[140:143], v[96:99]
    v_mfma_f32_16x16x32_bf16 v[100:103], v[80:83], v[144:147], v[100:103]
    s_waitcnt lgkmcnt(4)
    v_mfma_f32_16x16x32_bf16 v[104:107], v[88:91], v[140:143], v[104:107]
    v_mfma_f32_16x16x32_bf16 v[108:111], v[88:91], v[144:147], v[108:111]
    s_waitcnt lgkmcnt(3)
    v_mfma_f32_16x16x32_bf16 v[96:99], v[84:87], v[148:151], v[96:99]
    v_mfma_f32_16x16x32_bf16 v[100:103], v[84:87], v[140:143], v[100:103]
    s_waitcnt lgkmcnt(2)
    v_mfma_f32_16x16x32_bf16 v[104:107], v[92:95], v[148:151], v[104:107]
    v_mfma_f32_16x16x32_bf16 v[108:111], v[92:95], v[140:143], v[108:111]
    s_waitcnt lgkmcnt(1)
    v_mfma_f32_16x16x32_bf16 v[160:163], v[152:155], v[128:131], 0
    s_nop 2
    v_cvt_pk_bf16_f32 v112, v96, v100
    v_cvt_pk_bf16_f32 v113, v97, v101
    v_mfma_f32_16x16x32_bf16 v[164:167], v[152:155], v[132:135], 0
    v_cvt_pk_bf16_f32 v114, v98, v102
    v_cvt_pk_bf16_f32 v115, v99, v103
    s_waitcnt lgkmcnt(0)
    v_mfma_f32_16x16x32_bf16 v[160:163], v[156:159], v[140:143], v[160:163]
    ds_write_b128 v63, v[112:115]
    v_mfma_f32_16x16x32_bf16 v[164:167], v[156:159], v[144:147], v[164:167]
    v_cvt_pk_bf16_f32 v116, v104, v108
    v_cvt_pk_bf16_f32 v117, v105, v109
    v_cvt_pk_bf16_f32 v118, v106, v110
    v_cvt_pk_bf16_f32 v119, v107, v111
    ds_write_b128 v10, v[116:119]
    ds_read_b128 v[64:67], v3 offset:0
    ds_read_b128 v[68:71], v3 offset:1024
    s_nop 0
    v_cvt_pk_bf16_f32 v160, v160, v164
    s_waitcnt lgkmcnt(1)
    buffer_store_dwordx4 v[64:67], v7, s[28:31], s65 offen sc1
    s_add_u32 s62, s65, 0x40000
    s_waitcnt lgkmcnt(0)
    buffer_store_dwordx4 v[68:71], v7, s[28:31], s62 offen sc1
    s_mov_b64 exec, 0xffff
    buffer_store_dword v160, v14, s[28:31], s69 offen sc1
    s_mov_b64 exec, -1
    s_add_u32 s33, s33, 0x9e3779b1
    v_lshrrev_b32 v63, 3, v1
    v_lshlrev_b32 v63, 7, v63
    v_and_b32 v11, 7, v1
    v_lshl_add_u32 v63, v11, 4, v63
    s_lshl_b32 s32, s48, 10
    s_add_u32 s32, s32, 0x282000
    buffer_load_dword v11, v63, s[28:31], s32 offen sc1
    s_bitcmp1_b32 s55, 5
    s_mov_b32 exec_lo, 0x0f0f0f0f
    s_cselect_b32 exec_lo, 0xf0f0f0f0, exec_lo
    s_mov_b32 exec_hi, exec_lo
    s_and_b32 s59, s53, 3
    s_cmp_lg_u32 s59, 0
    s_cbranch_scc1 L_c1
    ds_write_b128 v12, v[192:195] offset:0
    ds_write_b128 v12, v[208:211] offset:128
    ds_write_b128 v12, v[224:227] offset:256
    ds_write_b128 v12, v[240:243] offset:384
L_c1:
    s_cmp_lg_u32 s59, 1
    s_cbranch_scc1 L_c2
    ds_write_b128 v12, v[196:199] offset:0
    ds_write_b128 v12, v[212:215] offset:128
    ds_write_b128 v12, v[228:231] offset:256
    ds_write_b128 v12, v[244:247] offset:384
L_c2:
    s_cmp_lg_u32 s59, 2
    s_cbranch_scc1 L_c3
    ds_write_b128 v12, v[200:203] offset:0
    ds_write_b128 v12, v[216:219] offset:128
    ds_write_b128 v12, v[232:235] offset:256
    ds_write_b128 v12, v[248:251] offset:384
L_c3:
    s_cmp_lg_u32 s59, 3
    s_cbranch_scc1 L_c4
    ds_write_b128 v12, v[204:207] offset:0
    ds_write_b128 v12, v[220:223] offset:128
    ds_write_b128 v12, v[236:239] offset:256
    ds_write_b128 v12, v[252:255] offset:384
L_c4:
    s_mov_b64 exec, -1
    ds_write_b32 v62, v48 offset:0
    ds_write_b32 v62, v49 offset:16
    ds_write_b32 v62, v50 offset:32
    ds_write_b32 v62, v51 offset:48
    v_mov_b32 v28, 1
    s_mov_b64 exec, 1
    ds_add_u32 v6, v28 offset:32
    s_mov_b64 exec, -1
    s_sub_u32 s62, 64, s55
    s_and_b32 s62, s62, 63
    s_cmp_ge_u32 s56, 8
    s_cselect_b32 s68, s62, s55
    s_cselect_b64 s[86:87], -1, 0
    s_lshl_b32 s68, s68, 15
    s_cmp_eq_u32 s55, 0
    s_cselect_b32 s62, 32, 31
    s_lshl_b32 s63, s56, 5
    v_sub_u32 v98, s62, v20
    v_cndmask_b32 v26, v20, v98, s[86:87]
    v_add_u32 v99, s63, v20
    v_sub_u32 v100, 0x200, v99
    v_cndmask_b32 v99, v99, v100, s[86:87]
    v_cvt_f32_u32 v64, v26
    v_cvt_f32_u32 v65, v21
    v_mul_f32 v64, 0x3d000000, v64
    v_mul_f32 v65, 4.0, v65
    v_mul_f32 v65, v65, v64
    v_fmamk_f32 v67, v64, 0x00000000, v65
    v_fmamk_f32 v70, v64, 0x3f800000, v65
    v_cos_f32 v68, v67
    v_sin_f32 v69, v67
    v_cos_f32 v71, v70
    v_sin_f32 v72, v70
    v_sub_u32 v100, 0x180, v99
    v_and_b32 v101, 0x7f, v99
    v_fmamk_f32 v73, v64, 0x40000000, v65
    v_fmamk_f32 v67, v64, 0x40400000, v65
    v_fmamk_f32 v70, v64, 0x41000000, v65
    v_cmp_lt_u32 vcc, 0x80, v99
    s_nop 1
    v_cndmask_b32 v101, v101, v100, vcc
    v_cvt_pk_bf16_f32 v160, v68, v69
    v_cvt_pk_bf16_f32 v161, v71, v72
    v_cos_f32 v74, v73
    v_sin_f32 v75, v73
    v_cos_f32 v68, v67
    v_sin_f32 v69, v67
    v_cos_f32 v71, v70
    v_sin_f32 v72, v70
    v_bfe_u32 v102, v101, 4, 3
    v_lshrrev_b32 v103, 7, v101
    v_lshl_add_u32 v102, v102, 1, v103
    v_and_b32 v101, 15, v101
    v_fmamk_f32 v73, v64, 0x41100000, v65
    v_fmamk_f32 v67, v64, 0x41200000, v65
    v_fmamk_f32 v70, v64, 0x41300000, v65
    v_cvt_pk_bf16_f32 v162, v74, v75
    v_cvt_pk_bf16_f32 v163, v68, v69
    v_cvt_pk_bf16_f32 v164, v71, v72
    v_lshl_add_u32 v101, v102, 4, v101
    v_cos_f32 v74, v73
    v_sin_f32 v75, v73
    v_cos_f32 v68, v67
    v_sin_f32 v69, v67
    v_cos_f32 v71, v70
    v_sin_f32 v72, v70
    v_lshlrev_b32 v9, 6, v20
    v_lshlrev_b32 v101, 2, v101
    v_mov_b32 v100, 0x1000000
    v_and_b32 v66, 1, v26
    v_lshl_add_u32 v9, v21, 3, v9
    s_lshr_b32 s62, s55, 5
    s_lshl_b32 s62, s62, 2
    s_add_u32 s62, s62, 0x27100
    v_lshl_add_u32 v24, v20, 3, s62
    v_cmp_eq_u32 vcc, 0, v99
    s_nop 1
    v_cndmask_b32 v101, v101, v100, vcc
    v_mul_u32_u24 v66, 0x8000, v66
    s_lshl_b32 s62, s48, 11
    s_add_u32 s62, s62, 0x23000
    v_add_u32 v9, s62, v9
    v_lshl_or_b32 v66, v66, 16, v66
    v_cvt_pk_bf16_f32 v165, v74, v75
    v_cvt_pk_bf16_f32 v166, v68, v69
    v_cvt_pk_bf16_f32 v167, v71, v72
    v_lshl_add_u32 v22, v21, 12, v101
    v_xor_b32 v168, v66, v160
    v_xor_b32 v169, v66, v161
    v_xor_b32 v170, v66, v162
    v_xor_b32 v171, v66, v163
    v_xor_b32 v172, v66, v164
    v_xor_b32 v173, v66, v165
    v_xor_b32 v174, v66, v166
    v_xor_b32 v175, v66, v167
    s_waitcnt lgkmcnt(0)
    v_lshlrev_b32 v23, 10, v21
    s_lshl_b32 s69, s55, 2
    s_add_u32 s69, s69, 0x360000
    s_mov_b32 s63, 0
L_s1:
    ds_read_b32 v29, v6 offset:32
    s_waitcnt lgkmcnt(0)
    v_cmp_gt_u32 vcc, 4, v29
    s_add_u32 s63, s63, 1
    s_cmp_gt_u32 s63, 100000
    s_cbranch_scc1 L_x1
    s_cbranch_vccnz L_s1
L_x1:
    ds_read_b64 v[120:121], v9 offset:0
    ds_read_b64 v[122:123], v9 offset:16
    ds_read_b64 v[124:125], v9 offset:32
    ds_read_b64 v[126:127], v9 offset:48
    ds_read_b32 v24, v24
    v_lshlrev_b32 v3, 9, v21
    v_bfe_u32 v54, v1, 2, 2
    v_lshl_add_u32 v3, v54, 6, v3
    v_bfe_u32 v54, v1, 4, 1
    v_lshl_add_u32 v3, v54, 5, v3
    v_and_b32 v54, 3, v1
    v_lshl_add_u32 v3, v54, 3, v3
    v_add_u32 v4, 0x10000, v3
    v_add_u32 v5, 0x20000, v3
    v_mov_b32 v28, 1
    s_waitcnt lgkmcnt(0)
    ds_write_b32 v8, v28
    v_lshlrev_b32 v32, 16, v120
    v_and_b32 v33, 0xffff0000, v120
    v_lshlrev_b32 v34, 16, v121
    v_and_b32 v35, 0xffff0000, v121
    v_lshlrev_b32 v36, 16, v122
    v_and_b32 v37, 0xffff0000, v122
    v_lshlrev_b32 v38, 16, v123
    v_and_b32 v39, 0xffff0000, v123
    v_lshlrev_b32 v40, 16, v124
    v_and_b32 v41, 0xffff0000, v124
    v_lshlrev_b32 v42, 16, v125
    v_and_b32 v43, 0xffff0000, v125
    v_lshlrev_b32 v44, 16, v126
    v_and_b32 v45, 0xffff0000, v126
    v_lshlrev_b32 v46, 16, v127
    v_and_b32 v47, 0xffff0000, v127
    v_mov_b32 v25, v32
    v_add_f32 v32, v32, v24
    v_add_f32 v33, v33, v24
    v_add_f32 v34, v34, v24
    v_add_f32 v35, v35, v24
    v_add_f32 v36, v36, v24
    v_add_f32 v37, v37, v24
    v_add_f32 v38, v38, v24
    v_add_f32 v39, v39, v24
    v_add_f32 v40, v40, v24
    v_add_f32 v41, v41, v24
    v_add_f32 v42, v42, v24
    v_add_f32 v43, v43, v24
    v_add_f32 v44, v44, v24
    v_add_f32 v45, v45, v24
    v_add_f32 v46, v46, v24
    v_add_f32 v47, v47, v24
    s_waitcnt vmcnt(0)
    v_cmp_ne_u32 vcc, s33, v11
    s_nop 0
    s_cbranch_vccnz L_o5
L_b5:
    s_mov_b64 exec, 1
    ds_add_u32 v6, v28 offset:36
    s_mov_b64 exec, -1
    s_mov_b32 s63, 0
L_s3:
    ds_read_b32 v29, v6 offset:36
    s_waitcnt lgkmcnt(0)
    v_cmp_gt_u32 vcc, 4, v29
    s_add_u32 s63, s63, 1
    s_cmp_gt_u32 s63, 100000
    s_cbranch_scc1 L_x3
    s_cbranch_vccnz L_s3
L_x3:
    s_cmp_lg_u32 s56, 0
    s_cselect_b32 exec_lo, -1, -2
    s_mov_b32 exec_hi, exec_lo
    buffer_load_dword v64, v22, s[28:31], s68 offen offset:0 sc1
    buffer_load_dword v65, v22, s[28:31], s68 offen offset:1024 sc1
    buffer_load_dword v66, v22, s[28:31], s68 offen offset:2048 sc1
    buffer_load_dword v67, v22, s[28:31], s68 offen offset:3072 sc1
    s_add_u32 s7, s68, 0x2000
    buffer_load_dword v68, v22, s[28:31], s7 offen offset:0 sc1
    buffer_load_dword v69, v22, s[28:31], s7 offen offset:1024 sc1
    buffer_load_dword v70, v22, s[28:31], s7 offen offset:2048 sc1
    buffer_load_dword v71, v22, s[28:31], s7 offen offset:3072 sc1
    s_add_u32 s7, s68, 0x4000
    buffer_load_dword v72, v22, s[28:31], s7 offen offset:0 sc1
    buffer_load_dword v73, v22, s[28:31], s7 offen offset:1024 sc1
    buffer_load_dword v74, v22, s[28:31], s7 offen offset:2048 sc1
    buffer_load_dword v75, v22, s[28:31], s7 offen offset:3072 sc1
    s_add_u32 s7, s68, 0x6000
    buffer_load_dword v76, v22, s[28:31], s7 offen offset:0 sc1
    buffer_load_dword v77, v22, s[28:31], s7 offen offset:1024 sc1
    buffer_load_dword v78, v22, s[28:31], s7 offen offset:2048 sc1
    buffer_load_dword v79, v22, s[28:31], s7 offen offset:3072 sc1
    s_cmp_lg_u32 s56, 0
    s_cbranch_scc1 L_nza
    s_mov_b32 exec_lo, 1
    s_mov_b32 exec_hi, 1
    s_add_u32 s83, s69, 0x1000
    buffer_load_dword v64, v23, s[28:31], s69 offen offset:0 sc1
    buffer_load_dword v65, v23, s[28:31], s69 offen offset:256 sc1
    buffer_load_dword v66, v23, s[28:31], s69 offen offset:512 sc1
    buffer_load_dword v67, v23, s[28:31], s69 offen offset:768 sc1
    buffer_load_dword v68, v23, s[28:31], s69 offen offset:2048 sc1
    buffer_load_dword v69, v23, s[28:31], s69 offen offset:2304 sc1
    buffer_load_dword v70, v23, s[28:31], s69 offen offset:2560 sc1
    buffer_load_dword v71, v23, s[28:31], s69 offen offset:2816 sc1
    buffer_load_dword v72, v23, s[28:31], s83 offen offset:0 sc1
    buffer_load_dword v73, v23, s[28:31], s83 offen offset:256 sc1
    buffer_load_dword v74, v23, s[28:31], s83 offen offset:512 sc1
    buffer_load_dword v75, v23, s[28:31], s83 offen offset:768 sc1
    buffer_load_dword v76, v23, s[28:31], s83 offen offset:2048 sc1
    buffer_load_dword v77, v23, s[28:31], s83 offen offset:2304 sc1
    buffer_load_dword v78, v23, s[28:31], s83 offen offset:2560 sc1
    buffer_load_dword v79, v23, s[28:31], s83 offen offset:2816 sc1
    s_mov_b64 exec, -1
L_nza:
    ds_read_b32 v31, v6 offset:44
    v_lshlrev_b32 v18, 7, v18
    s_add_u32 s32, s5, 0x80000
    buffer_load_dword v30, v18, s[28:31], s32 offen sc1
    s_waitcnt vmcnt(1)
    v_max3_u32 v29, v64, v65, v66
    v_max3_u32 v29, v29, v67, v68
    v_max3_u32 v29, v29, v69, v70
    v_max3_u32 v29, v29, v71, v72
    v_max3_u32 v29, v29, v73, v74
    v_max3_u32 v29, v29, v75, v76
    v_max3_u32 v29, v29, v77, v78
    v_max_u32 v29, v29, v79
    v_cmp_eq_u32 vcc, -1, v29
    s_nop 0
    s_cbranch_vccnz L_o6
L_b6:
    v_mfma_f32_32x32x16_bf16 v[32:47], v[64:67], v[160:163], v[32:47]
    v_mfma_f32_32x32x16_bf16 v[32:47], v[68:71], v[164:167], v[32:47]
    v_mfma_f32_32x32x16_bf16 v[32:47], v[72:75], v[168:171], v[32:47]
    v_mfma_f32_32x32x16_bf16 v[32:47], v[76:79], v[172:175], v[32:47]
    s_waitcnt lgkmcnt(0)
    v_cmp_gt_u32 vcc, 4, v31
    s_nop 0
    s_cbranch_vccnz L_o7
L_b7:
    s_nop 7
    v_cvt_pk_bf16_f32 v52, v32, v33
    v_cvt_pk_bf16_f32 v53, v34, v35
    v_cvt_pk_bf16_f32 v54, v36, v37
    v_cvt_pk_bf16_f32 v55, v38, v39
    buffer_store_dwordx4 v[52:55], v2, s[28:31], s66 offen offset:0 sc1
    v_cvt_pk_bf16_f32 v56, v40, v41
    v_cvt_pk_bf16_f32 v57, v42, v43
    v_cvt_pk_bf16_f32 v58, v44, v45
    v_cvt_pk_bf16_f32 v59, v46, v47
    buffer_store_dwordx4 v[56:59], v2, s[28:31], s66 offen offset:1024 sc1
    v_sub_f32 v25, v25, v32
    v_mul_f32 v60, v32, v32
    v_mul_f32 v61, v33, v33
    v_fmac_f32 v60, v34, v34
    v_fmac_f32 v61, v35, v35
    v_fmac_f32 v60, v36, v36
    v_fmac_f32 v61, v37, v37
    v_fmac_f32 v60, v38, v38
    v_fmac_f32 v61, v39, v39
    v_fmac_f32 v60, v40, v40
    v_fmac_f32 v61, v41, v41
    v_fmac_f32 v60, v42, v42
    v_fmac_f32 v61, v43, v43
    v_fmac_f32 v60, v44, v44
    v_fmac_f32 v61, v45, v45
    v_fmac_f32 v60, v46, v46
    v_fmac_f32 v61, v47, v47
    v_add_f32 v60, v60, v61
    s_nop 1
    v_permlane32_swap_b32 v60, v25
    s_mov_b64 exec, 0xffffffff
    v_add_f32 v60, v60, v25
    s_mov_b64 exec, -1
    buffer_store_dword v60, v16, s[28:31], s67 offen sc1
    v_lshl_add_u32 v9, v21, 10, v14
    v_mov_b32 v7, v14
    v_lshlrev_b32 v22, 10, v21
    v_bfe_u32 v23, v1, 2, 2
    v_lshl_add_u32 v22, v23, 7, v22
    v_and_b32 v23, 1, v1
    v_lshl_add_u32 v22, v23, 6, v22
    v_bfe_u32 v23, v1, 4, 1
    v_lshl_add_u32 v22, v23, 4, v22
    v_bfe_u32 v23, v1, 1, 1
    v_lshl_add_u32 v22, v23, 3, v22
    v_bfe_u32 v23, v1, 3, 1
    v_lshl_add_u32 v22, v23, 5, v22
    s_lshl_b32 s62, s74, 11
    v_add_u32 v10, s62, v22
    s_lshl_b32 s62, s74, 5
    s_xor_b32 s62, s62, 32
    v_xor_b32 v10, s62, v10
    v_lshlrev_b32 v11, 11, v21
    v_lshl_add_u32 v11, v20, 4, v11
    v_lshlrev_b32 v19, 16, v20
    v_lshl_add_u32 v19, v21, 6, v19
    s_and_b32 s62, s48, 1
    s_lshl_b32 s55, s54, 1
    s_add_u32 s55, s55, s62
    s_lshl_b32 s55, s55, 2
    s_add_u32 s55, s55, s52
    s_mul_i32 s72, s55, 98304
    s_lshl_b32 s62, s74, 10
    s_add_u32 s72, s72, s62
    s_add_u32 s72, s72, 0x600000
    s_lshl_b32 s5, s55, 11
    s_add_u32 s5, s5, 0x320000
    s_xor_b32 s62, s36, 0
    s_lshl_b32 s62, s62, 13
    s_add_u32 s42, s72, s62
    s_xor_b32 s62, s36, 1
    s_lshl_b32 s62, s62, 13
    s_add_u32 s43, s72, s62
    s_xor_b32 s62, s36, 2
    s_lshl_b32 s62, s62, 13
    s_add_u32 s44, s72, s62
    s_xor_b32 s62, s36, 3
    s_lshl_b32 s62, s62, 13
    s_add_u32 s45, s72, s62
    s_lshl_b32 s41, s41, 12
    s_waitcnt vmcnt(3)
    v_cmp_ne_u32 vcc, s33, v30
    s_nop 0
    s_cbranch_vccnz L_o8
L_b8:
    s_waitcnt vmcnt(0)
    s_add_u32 s78, s41, 0x0
    s_and_b32 s78, s78, 0x7fff
    s_add_u32 s78, s78, s82
    buffer_load_dwordx4 v[128:131], v2, s[28:31], s78 offen offset:0 sc1
    ds_read_b128 v[24:27], v6
    s_bitcmp1_b32 s48, 0
    s_cselect_b32 s7, 13, 8
    s_lshl_b32 s7, s7, 12
    s_lshl_b32 s68, s73, 7
    s_lshl_b32 s62, s55, 10
    s_add_u32 s68, s68, s62
    s_lshl_b32 s59, s73, 7
    s_lshl_b32 s62, s74, 5
    s_add_u32 s59, s59, s62
    s_lshl_b32 s62, s55, 10
    s_add_u32 s59, s59, s62
    s_lshl_b32 s62, s74, 20
    s_add_u32 s68, s68, s62
    s_add_u32 s69, s68, 0x80000
    buffer_load_dwordx4 v[132:135], v2, s[28:31], s78 offen offset:1024 sc1
    buffer_load_dwordx4 v[136:139], v2, s[28:31], s78 offen offset:2048 sc1
    s_waitcnt lgkmcnt(0)
    v_min3_u32 v24, v24, v25, v26
    v_min_u32 v24, v24, v27
    v_cmp_gt_u32 vcc, 8, v24
    s_nop 0
    s_cbranch_vccnz L_o9
L_b9:
    ds_read_b64_tr_b16 v[32:33], v3 offset:0
    ds_read_b64_tr_b16 v[34:35], v3 offset:256
    ds_read_b64_tr_b16 v[36:37], v3 offset:4096
    ds_read_b64_tr_b16 v[38:39], v3 offset:4352
    ds_read_b64_tr_b16 v[40:41], v3 offset:1024
    ds_read_b64_tr_b16 v[42:43], v3 offset:1280
    ds_read_b64_tr_b16 v[44:45], v3 offset:5120
    ds_read_b64_tr_b16 v[46:47], v3 offset:5376
    ds_read_b64_tr_b16 v[48:49], v3 offset:2048
    buffer_load_dwordx4 v[140:143], v2, s[28:31], s78 offen offset:3072 sc1
    ds_read_b64_tr_b16 v[50:51], v3 offset:2304
    ds_read_b64_tr_b16 v[52:53], v3 offset:6144
    ds_read_b64_tr_b16 v[54:55], v3 offset:6400
    ds_read_b64_tr_b16 v[56:57], v3 offset:3072
    ds_read_b64_tr_b16 v[58:59], v3 offset:3328
    ds_read_b64_tr_b16 v[60:61], v3 offset:7168
    ds_read_b64_tr_b16 v[62:63], v3 offset:7424
    s_add_u32 s78, s41, 0x1000
    s_and_b32 s78, s78, 0x7fff
    s_add_u32 s78, s78, s82
    buffer_load_dwordx4 v[144:147], v2, s[28:31], s78 offen offset:0 sc1
    buffer_load_dwordx4 v[148:151], v2, s[28:31], s78 offen offset:1024 sc1
    s_waitcnt lgkmcnt(12)
    buffer_load_dwordx4 v[152:155], v2, s[28:31], s78 offen offset:2048 sc1
    s_waitcnt lgkmcnt(8)
    s_waitcnt lgkmcnt(4)
    s_waitcnt lgkmcnt(0)
    buffer_load_dwordx4 v[156:159], v2, s[28:31], s78 offen offset:3072 sc1
    s_add_u32 s78, s41, 0x2000
    s_and_b32 s78, s78, 0x7fff
    s_add_u32 s78, s78, s82
    buffer_load_dwordx4 v[160:163], v2, s[28:31], s78 offen offset:0 sc1
    buffer_load_dwordx4 v[164:167], v2, s[28:31], s78 offen offset:1024 sc1
    buffer_load_dwordx4 v[168:171], v2, s[28:31], s78 offen offset:2048 sc1
    buffer_load_dwordx4 v[172:175], v2, s[28:31], s78 offen offset:3072 sc1
    s_waitcnt vmcnt(9)
    v_max3_u32 v29, v128, v132, v136
    s_add_u32 s78, s41, 0x3000
    s_and_b32 s78, s78, 0x7fff
    s_add_u32 s78, s78, s82
    buffer_load_dwordx4 v[176:179], v2, s[28:31], s78 offen offset:0 sc1
    s_waitcnt vmcnt(9)
    v_max_u32 v29, v29, v140
    v_cmp_eq_u32 vcc, -1, v29
    s_nop 0
    s_cbranch_vccnz L_o10
L_b10:
    v_mfma_f32_32x32x16_bf16 v[64:79], v[32:35], v[128:131], 0
    ds_read_b64_tr_b16 v[32:33], v3 offset:20480
    ds_read_b64_tr_b16 v[34:35], v3 offset:20736
    buffer_load_dwordx4 v[180:183], v2, s[28:31], s78 offen offset:1024 sc1
    v_mfma_f32_32x32x16_bf16 v[80:95], v[36:39], v[128:131], 0
    ds_read_b64_tr_b16 v[36:37], v3 offset:24576
    ds_read_b64_tr_b16 v[38:39], v3 offset:24832
    v_mfma_f32_32x32x16_bf16 v[64:79], v[40:43], v[132:135], v[64:79]
    ds_read_b64_tr_b16 v[40:41], v3 offset:21504
    ds_read_b64_tr_b16 v[42:43], v3 offset:21760
    buffer_load_dwordx4 v[184:187], v2, s[28:31], s78 offen offset:2048 sc1
    v_mfma_f32_32x32x16_bf16 v[80:95], v[44:47], v[132:135], v[80:95]
    ds_read_b64_tr_b16 v[44:45], v3 offset:25600
    ds_read_b64_tr_b16 v[46:47], v3 offset:25856
    v_mfma_f32_32x32x16_bf16 v[64:79], v[48:51], v[136:139], v[64:79]
    ds_read_b64_tr_b16 v[48:49], v3 offset:22528
    ds_read_b64_tr_b16 v[50:51], v3 offset:22784
    buffer_load_dwordx4 v[188:191], v2, s[28:31], s78 offen offset:3072 sc1
    v_mfma_f32_32x32x16_bf16 v[80:95], v[52:55], v[136:139], v[80:95]
    ds_read_b64_tr_b16 v[52:53], v3 offset:26624
    ds_read_b64_tr_b16 v[54:55], v3 offset:26880
    s_waitcnt vmcnt(9)
    v_max3_u32 v29, v144, v148, v152
    v_mfma_f32_32x32x16_bf16 v[64:79], v[56:59], v[140:143], v[64:79]
    ds_read_b64_tr_b16 v[56:57], v3 offset:23552
    s_add_u32 s78, s41, 0x4000
    s_and_b32 s78, s78, 0x7fff
    s_add_u32 s78, s78, s82
    buffer_load_dwordx4 v[192:195], v2, s[28:31], s78 offen offset:0 sc1
    ds_read_b64_tr_b16 v[58:59], v3 offset:23808
    v_mfma_f32_32x32x16_bf16 v[80:95], v[60:63], v[140:143], v[80:95]
    ds_read_b64_tr_b16 v[60:61], v3 offset:27648
    ds_read_b64_tr_b16 v[62:63], v3 offset:27904
    v_mov_b32 v28, 2
    ds_write_b32 v8, v28
    s_waitcnt lgkmcnt(13)
    s_waitcnt vmcnt(9)
    v_max_u32 v29, v29, v156
    v_cmp_eq_u32 vcc, -1, v29
    s_nop 0
    s_cbranch_vccnz L_o11
L_b11:
    v_mfma_f32_32x32x16_bf16 v[64:79], v[32:35], v[144:147], v[64:79]
    buffer_load_dwordx4 v[196:199], v2, s[28:31], s78 offen offset:1024 sc1
    ds_read_b64_tr_b16 v[32:33], v3 offset:40960
    ds_read_b64_tr_b16 v[34:35], v3 offset:41216
    s_waitcnt lgkmcnt(11)
    v_mfma_f32_32x32x16_bf16 v[80:95], v[36:39], v[144:147], v[80:95]
    ds_read_b64_tr_b16 v[36:37], v3 offset:45056
    ds_read_b64_tr_b16 v[38:39], v3 offset:45312
    v_mfma_f32_32x32x16_bf16 v[64:79], v[40:43], v[148:151], v[64:79]
    buffer_load_dwordx4 v[200:203], v2, s[28:31], s78 offen offset:2048 sc1
    ds_read_b64_tr_b16 v[40:41], v3 offset:41984
    ds_read_b64_tr_b16 v[42:43], v3 offset:42240
    s_waitcnt lgkmcnt(11)
    v_mfma_f32_32x32x16_bf16 v[80:95], v[44:47], v[148:151], v[80:95]
    ds_read_b64_tr_b16 v[44:45], v3 offset:46080
    ds_read_b64_tr_b16 v[46:47], v3 offset:46336
    v_mfma_f32_32x32x16_bf16 v[64:79], v[48:51], v[152:155], v[64:79]
    buffer_load_dwordx4 v[204:207], v2, s[28:31], s78 offen offset:3072 sc1
    ds_read_b64_tr_b16 v[48:49], v3 offset:43008
    ds_read_b64_tr_b16 v[50:51], v3 offset:43264
    s_waitcnt vmcnt(9)
    v_max3_u32 v29, v160, v164, v168
    s_waitcnt lgkmcnt(11)
    v_mfma_f32_32x32x16_bf16 v[80:95], v[52:55], v[152:155], v[80:95]
    ds_read_b64_tr_b16 v[52:53], v3 offset:47104
    ds_read_b64_tr_b16 v[54:55], v3 offset:47360
    v_mfma_f32_32x32x16_bf16 v[64:79], v[56:59], v[156:159], v[64:79]
    buffer_load_dword v96, v9, s[28:31], s6 offen offset:0 sc1
    ds_read_b64_tr_b16 v[56:57], v3 offset:44032
    ds_read_b64_tr_b16 v[58:59], v3 offset:44288
    s_waitcnt vmcnt(9)
    v_max_u32 v29, v29, v172
    v_mfma_f32_32x32x16_bf16 v[80:95], v[60:63], v[156:159], v[80:95]
    buffer_load_dword v97, v9, s[28:31], s6 offen offset:128 sc1
    ds_read_b64_tr_b16 v[60:61], v3 offset:48128
    ds_read_b64_tr_b16 v[62:63], v3 offset:48384
    s_waitcnt lgkmcnt(12)
    v_cmp_eq_u32 vcc, -1, v29
    s_nop 0
    s_cbranch_vccnz L_o12
L_b12:
    v_mfma_f32_32x32x16_bf16 v[64:79], v[32:35], v[160:163], v[64:79]
    buffer_load_dword v98, v9, s[28:31], s6 offen offset:256 sc1
    ds_read_b64_tr_b16 v[32:33], v3 offset:61440
    ds_read_b64_tr_b16 v[34:35], v3 offset:61696
    v_mfma_f32_32x32x16_bf16 v[80:95], v[36:39], v[160:163], v[80:95]
    buffer_load_dword v99, v9, s[28:31], s6 offen offset:384 sc1
    ds_read_b64_tr_b16 v[36:37], v4 offset:0
    ds_read_b64_tr_b16 v[38:39], v4 offset:256
    s_waitcnt lgkmcnt(12)
    v_mfma_f32_32x32x16_bf16 v[64:79], v[40:43], v[164:167], v[64:79]
    buffer_load_dword v100, v9, s[28:31], s6 offen offset:512 sc1
    ds_read_b64_tr_b16 v[40:41], v3 offset:62464
    ds_read_b64_tr_b16 v[42:43], v3 offset:62720
    v_mfma_f32_32x32x16_bf16 v[80:95], v[44:47], v[164:167], v[80:95]
    buffer_load_dword v101, v9, s[28:31], s6 offen offset:640 sc1
    ds_read_b64_tr_b16 v[44:45], v4 offset:1024
    ds_read_b64_tr_b16 v[46:47], v4 offset:1280
    s_waitcnt lgkmcnt(12)
    v_mfma_f32_32x32x16_bf16 v[64:79], v[48:51], v[168:171], v[64:79]
    buffer_load_dword v102, v9, s[28:31], s6 offen offset:768 sc1
    ds_read_b64_tr_b16 v[48:49], v3 offset:63488
    ds_read_b64_tr_b16 v[50:51], v3 offset:63744
    s_waitcnt vmcnt(12)
    v_max3_u32 v29, v176, v180, v184
    v_mfma_f32_32x32x16_bf16 v[80:95], v[52:55], v[168:171], v[80:95]
    buffer_load_dword v103, v9, s[28:31], s6 offen offset:896 sc1
    ds_read_b64_tr_b16 v[52:53], v4 offset:2048
    ds_read_b64_tr_b16 v[54:55], v4 offset:2304
    s_waitcnt lgkmcnt(12)
    s_add_u32 s78, s41, 0x5000
    s_and_b32 s78, s78, 0x7fff
    s_add_u32 s78, s78, s82
    buffer_load_dwordx4 v[208:211], v2, s[28:31], s78 offen offset:0 sc1
    v_mfma_f32_32x32x16_bf16 v[64:79], v[56:59], v[172:175], v[64:79]
    ds_read_b64_tr_b16 v[56:57], v3 offset:64512
    ds_read_b64_tr_b16 v[58:59], v3 offset:64768
    s_waitcnt vmcnt(13)
    v_max_u32 v29, v29, v188
    v_cmp_eq_u32 vcc, -1, v29
    s_nop 0
    s_cbranch_vccnz L_o13
L_b13:
    v_mfma_f32_32x32x16_bf16 v[80:95], v[60:63], v[172:175], v[80:95]
    ds_read_b64_tr_b16 v[60:61], v4 offset:3072
    ds_read_b64_tr_b16 v[62:63], v4 offset:3328
    v_mov_b32 v28, 3
    ds_write_b32 v8, v28
    buffer_load_dwordx4 v[212:215], v2, s[28:31], s78 offen offset:1024 sc1
    s_waitcnt lgkmcnt(13)
    v_mfma_f32_32x32x16_bf16 v[64:79], v[32:35], v[176:179], v[64:79]
    ds_read_b64_tr_b16 v[32:33], v4 offset:16384
    ds_read_b64_tr_b16 v[34:35], v4 offset:16640
    v_mfma_f32_32x32x16_bf16 v[80:95], v[36:39], v[176:179], v[80:95]
    ds_read_b64_tr_b16 v[36:37], v4 offset:20480
    ds_read_b64_tr_b16 v[38:39], v4 offset:20736
    s_waitcnt lgkmcnt(13)
    buffer_load_dwordx4 v[216:219], v2, s[28:31], s78 offen offset:2048 sc1
    v_mfma_f32_32x32x16_bf16 v[64:79], v[40:43], v[180:183], v[64:79]
    ds_read_b64_tr_b16 v[40:41], v4 offset:17408
    ds_read_b64_tr_b16 v[42:43], v4 offset:17664
    v_mfma_f32_32x32x16_bf16 v[80:95], v[44:47], v[180:183], v[80:95]
    ds_read_b64_tr_b16 v[44:45], v4 offset:21504
    ds_read_b64_tr_b16 v[46:47], v4 offset:21760
    s_waitcnt lgkmcnt(13)
    buffer_load_dwordx4 v[220:223], v2, s[28:31], s78 offen offset:3072 sc1
    v_mfma_f32_32x32x16_bf16 v[64:79], v[48:51], v[184:187], v[64:79]
    ds_read_b64_tr_b16 v[48:49], v4 offset:18432
    ds_read_b64_tr_b16 v[50:51], v4 offset:18688
    s_waitcnt vmcnt(13)
    v_max3_u32 v29, v192, v196, v200
    v_mfma_f32_32x32x16_bf16 v[80:95], v[52:55], v[184:187], v[80:95]
    ds_read_b64_tr_b16 v[52:53], v4 offset:22528
    ds_read_b64_tr_b16 v[54:55], v4 offset:22784
    s_add_u32 s78, s41, 0x6000
    s_and_b32 s78, s78, 0x7fff
    s_add_u32 s78, s78, s82
    buffer_load_dwordx4 v[224:227], v2, s[28:31], s78 offen offset:0 sc1
    s_waitcnt lgkmcnt(13)
    v_mfma_f32_32x32x16_bf16 v[64:79], v[56:59], v[188:191], v[64:79]
    ds_read_b64_tr_b16 v[56:57], v4 offset:19456
    ds_read_b64_tr_b16 v[58:59], v4 offset:19712
    s_waitcnt vmcnt(13)
    v_max_u32 v29, v29, v204
    v_cmp_eq_u32 vcc, -1, v29
    s_nop 0
    s_cbranch_vccnz L_o14
L_b14:
    v_mfma_f32_32x32x16_bf16 v[80:95], v[60:63], v[188:191], v[80:95]
    ds_read_b64_tr_b16 v[60:61], v4 offset:23552
    ds_read_b64_tr_b16 v[62:63], v4 offset:23808
    s_waitcnt lgkmcnt(12)
    buffer_load_dwordx4 v[228:231], v2, s[28:31], s78 offen offset:1024 sc1
    v_mfma_f32_32x32x16_bf16 v[64:79], v[32:35], v[192:195], v[64:79]
    ds_read_b64_tr_b16 v[32:33], v4 offset:36864
    ds_read_b64_tr_b16 v[34:35], v4 offset:37120
    v_mfma_f32_32x32x16_bf16 v[80:95], v[36:39], v[192:195], v[80:95]
    ds_read_b64_tr_b16 v[36:37], v4 offset:40960
    ds_read_b64_tr_b16 v[38:39], v4 offset:41216
    s_waitcnt lgkmcnt(12)
    buffer_load_dwordx4 v[232:235], v2, s[28:31], s78 offen offset:2048 sc1
    v_mfma_f32_32x32x16_bf16 v[64:79], v[40:43], v[196:199], v[64:79]
    ds_read_b64_tr_b16 v[40:41], v4 offset:37888
    ds_read_b64_tr_b16 v[42:43], v4 offset:38144
    v_mfma_f32_32x32x16_bf16 v[80:95], v[44:47], v[196:199], v[80:95]
    ds_read_b64_tr_b16 v[44:45], v4 offset:41984
    ds_read_b64_tr_b16 v[46:47], v4 offset:42240
    s_waitcnt lgkmcnt(12)
    buffer_load_dwordx4 v[236:239], v2, s[28:31], s78 offen offset:3072 sc1
    v_mfma_f32_32x32x16_bf16 v[64:79], v[48:51], v[200:203], v[64:79]
    ds_read_b64_tr_b16 v[48:49], v4 offset:38912
    ds_read_b64_tr_b16 v[50:51], v4 offset:39168
    v_mfma_f32_32x32x16_bf16 v[80:95], v[52:55], v[200:203], v[80:95]
    ds_read_b64_tr_b16 v[52:53], v4 offset:43008
    ds_read_b64_tr_b16 v[54:55], v4 offset:43264
    s_add_u32 s78, s41, 0x7000
    s_and_b32 s78, s78, 0x7fff
    s_add_u32 s78, s78, s82
    buffer_load_dwordx4 v[240:243], v2, s[28:31], s78 offen offset:0 sc1
    s_waitcnt lgkmcnt(12)
    v_mfma_f32_32x32x16_bf16 v[64:79], v[56:59], v[204:207], v[64:79]
    ds_read_b64_tr_b16 v[56:57], v4 offset:39936
    ds_read_b64_tr_b16 v[58:59], v4 offset:40192
    v_mfma_f32_32x32x16_bf16 v[80:95], v[60:63], v[204:207], v[80:95]
    ds_read_b64_tr_b16 v[60:61], v4 offset:44032
    ds_read_b64_tr_b16 v[62:63], v4 offset:44288
    v_mov_b32 v28, 4
    ds_write_b32 v8, v28
    buffer_load_dwordx4 v[244:247], v2, s[28:31], s78 offen offset:1024 sc1
    s_waitcnt lgkmcnt(13)
    s_waitcnt lgkmcnt(9)
    buffer_load_dwordx4 v[248:251], v2, s[28:31], s78 offen offset:2048 sc1
    s_waitcnt lgkmcnt(5)
    buffer_load_dwordx4 v[252:255], v2, s[28:31], s78 offen offset:3072 sc1
    s_waitcnt vmcnt(9)
    v_max3_u32 v29, v208, v212, v216
    s_waitcnt lgkmcnt(1)
    s_waitcnt vmcnt(8)
    v_max_u32 v29, v29, v220
    v_cmp_eq_u32 vcc, -1, v29
    s_nop 0
    s_cbranch_vccnz L_o15
L_b15:
    v_mfma_f32_32x32x16_bf16 v[64:79], v[32:35], v[208:211], v[64:79]
    ds_read_b64_tr_b16 v[32:33], v4 offset:57344
    ds_read_b64_tr_b16 v[34:35], v4 offset:57600
    v_mfma_f32_32x32x16_bf16 v[80:95], v[36:39], v[208:211], v[80:95]
    ds_read_b64_tr_b16 v[36:37], v4 offset:61440
    ds_read_b64_tr_b16 v[38:39], v4 offset:61696
    v_mfma_f32_32x32x16_bf16 v[64:79], v[40:43], v[212:215], v[64:79]
    ds_read_b64_tr_b16 v[40:41], v4 offset:58368
    ds_read_b64_tr_b16 v[42:43], v4 offset:58624
    v_mfma_f32_32x32x16_bf16 v[80:95], v[44:47], v[212:215], v[80:95]
    ds_read_b64_tr_b16 v[44:45], v4 offset:62464
    ds_read_b64_tr_b16 v[46:47], v4 offset:62720
    v_mfma_f32_32x32x16_bf16 v[64:79], v[48:51], v[216:219], v[64:79]
    ds_read_b64_tr_b16 v[48:49], v4 offset:59392
    ds_read_b64_tr_b16 v[50:51], v4 offset:59648
    v_mfma_f32_32x32x16_bf16 v[80:95], v[52:55], v[216:219], v[80:95]
    ds_read_b64_tr_b16 v[52:53], v4 offset:63488
    ds_read_b64_tr_b16 v[54:55], v4 offset:63744
    s_waitcnt vmcnt(5)
    v_max3_u32 v29, v224, v228, v232
    v_mfma_f32_32x32x16_bf16 v[64:79], v[56:59], v[220:223], v[64:79]
    ds_read_b64_tr_b16 v[56:57], v4 offset:60416
    ds_read_b64_tr_b16 v[58:59], v4 offset:60672
    v_mfma_f32_32x32x16_bf16 v[80:95], v[60:63], v[220:223], v[80:95]
    ds_read_b64_tr_b16 v[60:61], v4 offset:64512
    ds_read_b64_tr_b16 v[62:63], v4 offset:64768
    s_waitcnt vmcnt(4)
    v_max_u32 v29, v29, v236
    v_cmp_eq_u32 vcc, -1, v29
    s_nop 0
    s_cbranch_vccnz L_o16
L_b16:
    s_waitcnt lgkmcnt(12)
    v_mfma_f32_32x32x16_bf16 v[64:79], v[32:35], v[224:227], v[64:79]
    ds_read_b64_tr_b16 v[32:33], v5 offset:12288
    ds_read_b64_tr_b16 v[34:35], v5 offset:12544
    v_mfma_f32_32x32x16_bf16 v[80:95], v[36:39], v[224:227], v[80:95]
    ds_read_b64_tr_b16 v[36:37], v5 offset:16384
    ds_read_b64_tr_b16 v[38:39], v5 offset:16640
    ds_read_b128 v[24:27], v6
    s_waitcnt lgkmcnt(13)
    v_mfma_f32_32x32x16_bf16 v[64:79], v[40:43], v[228:231], v[64:79]
    ds_read_b64_tr_b16 v[40:41], v5 offset:13312
    ds_read_b64_tr_b16 v[42:43], v5 offset:13568
    v_mfma_f32_32x32x16_bf16 v[80:95], v[44:47], v[228:231], v[80:95]
    ds_read_b64_tr_b16 v[44:45], v5 offset:17408
    ds_read_b64_tr_b16 v[46:47], v5 offset:17664
    s_waitcnt lgkmcnt(13)
    v_mfma_f32_32x32x16_bf16 v[64:79], v[48:51], v[232:235], v[64:79]
    ds_read_b64_tr_b16 v[48:49], v5 offset:14336
    ds_read_b64_tr_b16 v[50:51], v5 offset:14592
    v_mfma_f32_32x32x16_bf16 v[80:95], v[52:55], v[232:235], v[80:95]
    ds_read_b64_tr_b16 v[52:53], v5 offset:18432
    ds_read_b64_tr_b16 v[54:55], v5 offset:18688
    s_waitcnt lgkmcnt(13)
    s_waitcnt lgkmcnt(8)
    v_min3_u32 v24, v24, v25, v26
    v_min_u32 v24, v24, v27
    v_cmp_gt_u32 vcc, 9, v24
    s_nop 0
    s_cbranch_vccnz L_o18
L_b18:
    v_mfma_f32_32x32x16_bf16 v[64:79], v[56:59], v[236:239], v[64:79]
    ds_read_b64_tr_b16 v[56:57], v5 offset:15360
    ds_read_b64_tr_b16 v[58:59], v5 offset:15616
    s_waitcnt vmcnt(1)
    v_max3_u32 v29, v240, v244, v248
    v_mfma_f32_32x32x16_bf16 v[80:95], v[60:63], v[236:239], v[80:95]
    ds_read_b64_tr_b16 v[60:61], v5 offset:19456
    ds_read_b64_tr_b16 v[62:63], v5 offset:19712
    v_mov_b32 v28, 5
    ds_write_b32 v8, v28
    s_waitcnt vmcnt(0)
    v_max_u32 v29, v29, v252
    v_cmp_eq_u32 vcc, -1, v29
    s_nop 0
    s_cbranch_vccnz L_o17
L_b17:
    v_max3_u32 v29, v96, v97, v98
    v_mfma_f32_32x32x16_bf16 v[64:79], v[32:35], v[240:243], v[64:79]
    ds_read_b64_tr_b16 v[32:33], v3 offset:12288
    ds_read_b64_tr_b16 v[34:35], v3 offset:12544
    v_max3_u32 v29, v29, v99, v100
    v_max3_u32 v29, v29, v101, v102
    s_waitcnt lgkmcnt(11)
    v_max_u32 v29, v29, v103
    v_mfma_f32_32x32x16_bf16 v[80:95], v[36:39], v[240:243], v[80:95]
    ds_read_b64_tr_b16 v[36:37], v3 offset:13312
    ds_read_b64_tr_b16 v[38:39], v3 offset:13568
    v_cmp_eq_u32 vcc, -1, v29
    s_nop 0
    s_cbranch_vccnz L_o19
L_b19:
    v_add_f32 v96, v96, v97
    v_mfma_f32_32x32x16_bf16 v[64:79], v[40:43], v[244:247], v[64:79]
    ds_read_b64_tr_b16 v[40:41], v3 offset:14336
    ds_read_b64_tr_b16 v[42:43], v3 offset:14592
    s_mul_i32 s6, s55, 2176
    s_add_u32 s6, s6, 0x290000
    v_add_f32 v98, v98, v99
    s_waitcnt lgkmcnt(11)
    v_add_f32 v100, v100, v101
    v_mfma_f32_32x32x16_bf16 v[80:95], v[44:47], v[244:247], v[80:95]
    ds_read_b64_tr_b16 v[44:45], v3 offset:15360
    ds_read_b64_tr_b16 v[46:47], v3 offset:15616
    v_add_f32 v102, v102, v103
    v_add_f32 v96, v96, v98
    v_add_f32 v100, v100, v102
    v_add_f32 v96, v96, v100
    v_mfma_f32_32x32x16_bf16 v[64:79], v[48:51], v[248:251], v[64:79]
    ds_read_b64_tr_b16 v[48:49], v3 offset:32768
    ds_read_b64_tr_b16 v[50:51], v3 offset:33024
    v_mov_b32 v97, v96
    s_nop 1
    v_permlane32_swap_b32 v97, v97
    s_waitcnt lgkmcnt(11)
    v_mfma_f32_32x32x16_bf16 v[80:95], v[52:55], v[248:251], v[80:95]
    ds_read_b64_tr_b16 v[52:53], v3 offset:33792
    ds_read_b64_tr_b16 v[54:55], v3 offset:34048
    v_add_f32 v96, v96, v97
    v_mov_b32 v97, 0x3727c5ac
    v_fmamk_f32 v17, v96, 0x3b000000, v97
    v_lshrrev_b32 v9, 5, v1
    v_mfma_f32_32x32x16_bf16 v[64:79], v[56:59], v[252:255], v[64:79]
    ds_read_b64_tr_b16 v[56:57], v3 offset:34816
    ds_read_b64_tr_b16 v[58:59], v3 offset:35072
    v_rsq_f32 v16, v17
    v_lshlrev_b32 v9, 2, v9
    v_mul_f32 v16, 0xbfb8aa3b, v16
    v_mfma_f32_32x32x16_bf16 v[80:95], v[60:63], v[252:255], v[80:95]
    ds_read_b64_tr_b16 v[60:61], v3 offset:35840
    ds_read_b64_tr_b16 v[62:63], v3 offset:36096
    s_lshl_b32 s82, s55, 15
    s_lshl_b32 s62, s73, 12
    s_add_u32 s82, s82, s62
    s_lshl_b32 s62, s74, 10
    s_add_u32 s82, s82, s62
    s_add_u32 s82, s82, 0x400000
    s_waitcnt lgkmcnt(12)
    v_mfma_f32_32x32x16_bf16 v[96:111], v[32:35], v[128:131], 0
    ds_read_b64_tr_b16 v[32:33], v3 offset:53248
    ds_read_b64_tr_b16 v[34:35], v3 offset:53504
    v_mul_f32 v112, v16, v64
    v_mul_f32 v113, v16, v65
    v_mul_f32 v114, v16, v66
    v_mul_f32 v115, v16, v67
    v_mfma_f32_32x32x16_bf16 v[96:111], v[36:39], v[132:135], v[96:111]
    ds_read_b64_tr_b16 v[36:37], v3 offset:54272
    ds_read_b64_tr_b16 v[38:39], v3 offset:54528
    s_waitcnt lgkmcnt(12)
    v_mul_f32 v116, v16, v68
    v_mul_f32 v117, v16, v69
    v_mul_f32 v118, v16, v70
    v_mul_f32 v119, v16, v71
    v_mfma_f32_32x32x16_bf16 v[96:111], v[40:43], v[136:139], v[96:111]
    ds_read_b64_tr_b16 v[40:41], v3 offset:55296
    ds_read_b64_tr_b16 v[42:43], v3 offset:55552
    v_exp_f32 v112, v112
    v_exp_f32 v113, v113
    v_mfma_f32_32x32x16_bf16 v[96:111], v[44:47], v[140:143], v[96:111]
    ds_read_b64_tr_b16 v[44:45], v3 offset:56320
    ds_read_b64_tr_b16 v[46:47], v3 offset:56576
    s_waitcnt lgkmcnt(12)
    v_exp_f32 v114, v114
    v_exp_f32 v115, v115
    v_mfma_f32_32x32x16_bf16 v[96:111], v[48:51], v[144:147], v[96:111]
    ds_read_b64_tr_b16 v[48:49], v4 offset:8192
    ds_read_b64_tr_b16 v[50:51], v4 offset:8448
    v_exp_f32 v116, v116
    v_exp_f32 v117, v117
    v_mfma_f32_32x32x16_bf16 v[96:111], v[52:55], v[148:151], v[96:111]
    ds_read_b64_tr_b16 v[52:53], v4 offset:9216
    ds_read_b64_tr_b16 v[54:55], v4 offset:9472
    s_waitcnt lgkmcnt(12)
    v_exp_f32 v118, v118
    v_exp_f32 v119, v119
    v_mfma_f32_32x32x16_bf16 v[96:111], v[56:59], v[152:155], v[96:111]
    ds_read_b64_tr_b16 v[56:57], v4 offset:10240
    ds_read_b64_tr_b16 v[58:59], v4 offset:10496
    v_fma_f32 v112, v112, v17, v17
    v_fma_f32 v113, v113, v17, v17
    v_fma_f32 v114, v114, v17, v17
    v_fma_f32 v115, v115, v17, v17
    v_mfma_f32_32x32x16_bf16 v[96:111], v[60:63], v[156:159], v[96:111]
    ds_read_b64_tr_b16 v[60:61], v4 offset:11264
    ds_read_b64_tr_b16 v[62:63], v4 offset:11520
    v_mov_b32 v28, 6
    ds_write_b32 v8, v28
    s_waitcnt lgkmcnt(13)
    v_mfma_f32_32x32x16_bf16 v[96:111], v[32:35], v[160:163], v[96:111]
    ds_read_b64_tr_b16 v[32:33], v4 offset:28672
    ds_read_b64_tr_b16 v[34:35], v4 offset:28928
    v_fma_f32 v116, v116, v17, v17
    v_fma_f32 v117, v117, v17, v17
    v_fma_f32 v118, v118, v17, v17
    v_fma_f32 v119, v119, v17, v17
    v_mfma_f32_32x32x16_bf16 v[96:111], v[36:39], v[164:167], v[96:111]
    ds_read_b64_tr_b16 v[36:37], v4 offset:29696
    ds_read_b64_tr_b16 v[38:39], v4 offset:29952
    v_rcp_f32 v112, v112
    s_waitcnt lgkmcnt(13)
    v_mul_f32 v64, v64, v112
    v_mfma_f32_32x32x16_bf16 v[96:111], v[40:43], v[168:171], v[96:111]
    ds_read_b64_tr_b16 v[40:41], v4 offset:30720
    ds_read_b64_tr_b16 v[42:43], v4 offset:30976
    v_rcp_f32 v113, v113
    v_rcp_f32 v114, v114
    v_mfma_f32_32x32x16_bf16 v[96:111], v[44:47], v[172:175], v[96:111]
    ds_read_b64_tr_b16 v[44:45], v4 offset:31744
    ds_read_b64_tr_b16 v[46:47], v4 offset:32000
    v_rcp_f32 v115, v115
    s_waitcnt lgkmcnt(13)
    v_mul_f32 v65, v65, v113
    v_mfma_f32_32x32x16_bf16 v[96:111], v[48:51], v[176:179], v[96:111]
    ds_read_b64_tr_b16 v[48:49], v4 offset:49152
    ds_read_b64_tr_b16 v[50:51], v4 offset:49408
    v_rcp_f32 v116, v116
    v_rcp_f32 v117, v117
    v_mfma_f32_32x32x16_bf16 v[96:111], v[52:55], v[180:183], v[96:111]
    ds_read_b64_tr_b16 v[52:53], v4 offset:50176
    ds_read_b64_tr_b16 v[54:55], v4 offset:50432
    v_rcp_f32 v118, v118
    s_waitcnt lgkmcnt(13)
    v_mul_f32 v66, v66, v114
    v_mfma_f32_32x32x16_bf16 v[96:111], v[56:59], v[184:187], v[96:111]
    ds_read_b64_tr_b16 v[56:57], v4 offset:51200
    ds_read_b64_tr_b16 v[58:59], v4 offset:51456
    v_rcp_f32 v119, v119
    v_mul_f32 v67, v67, v115
    v_mul_f32 v68, v68, v116
    v_mfma_f32_32x32x16_bf16 v[96:111], v[60:63], v[188:191], v[96:111]
    ds_read_b64_tr_b16 v[60:61], v4 offset:52224
    ds_read_b64_tr_b16 v[62:63], v4 offset:52480
    v_mul_f32 v69, v69, v117
    s_waitcnt lgkmcnt(12)
    v_mul_f32 v70, v70, v118
    v_mul_f32 v71, v71, v119
    v_mfma_f32_32x32x16_bf16 v[96:111], v[32:35], v[192:195], v[96:111]
    ds_read_b64_tr_b16 v[32:33], v5 offset:4096
    ds_read_b64_tr_b16 v[34:35], v5 offset:4352
    v_mul_f32 v112, v16, v72
    v_mul_f32 v113, v16, v73
    v_mul_f32 v114, v16, v74
    v_mul_f32 v115, v16, v75
    v_mfma_f32_32x32x16_bf16 v[96:111], v[36:39], v[196:199], v[96:111]
    ds_read_b64_tr_b16 v[36:37], v5 offset:5120
    ds_read_b64_tr_b16 v[38:39], v5 offset:5376
    v_mul_f32 v116, v16, v76
    s_waitcnt lgkmcnt(12)
    v_mul_f32 v117, v16, v77
    v_mul_f32 v118, v16, v78
    v_mfma_f32_32x32x16_bf16 v[96:111], v[40:43], v[200:203], v[96:111]
    ds_read_b64_tr_b16 v[40:41], v5 offset:6144
    ds_read_b64_tr_b16 v[42:43], v5 offset:6400
    v_mul_f32 v119, v16, v79
    v_exp_f32 v112, v112
    v_mfma_f32_32x32x16_bf16 v[96:111], v[44:47], v[204:207], v[96:111]
    ds_read_b64_tr_b16 v[44:45], v5 offset:7168
    ds_read_b64_tr_b16 v[46:47], v5 offset:7424
    v_exp_f32 v113, v113
    s_waitcnt lgkmcnt(12)
    v_fma_f32 v112, v112, v17, v17
    v_mfma_f32_32x32x16_bf16 v[96:111], v[48:51], v[208:211], v[96:111]
    ds_read_b64_tr_b16 v[48:49], v5 offset:24576
    ds_read_b64_tr_b16 v[50:51], v5 offset:24832
    v_exp_f32 v114, v114
    v_exp_f32 v115, v115
    v_mfma_f32_32x32x16_bf16 v[96:111], v[52:55], v[212:215], v[96:111]
    ds_read_b64_tr_b16 v[52:53], v5 offset:25600
    ds_read_b64_tr_b16 v[54:55], v5 offset:25856
    v_exp_f32 v116, v116
    s_waitcnt lgkmcnt(12)
    v_fma_f32 v113, v113, v17, v17
    v_mfma_f32_32x32x16_bf16 v[96:111], v[56:59], v[216:219], v[96:111]
    ds_read_b64_tr_b16 v[56:57], v5 offset:26624
    ds_read_b64_tr_b16 v[58:59], v5 offset:26880
    v_exp_f32 v117, v117
    v_exp_f32 v118, v118
    v_mfma_f32_32x32x16_bf16 v[96:111], v[60:63], v[220:223], v[96:111]
    ds_read_b64_tr_b16 v[60:61], v5 offset:27648
    ds_read_b64_tr_b16 v[62:63], v5 offset:27904
    v_mov_b32 v28, 7
    ds_write_b32 v8, v28
    s_waitcnt lgkmcnt(13)
    v_mfma_f32_32x32x16_bf16 v[96:111], v[32:35], v[224:227], v[96:111]
    ds_read_b64_tr_b16 v[32:33], v3 offset:8192
    ds_read_b64_tr_b16 v[34:35], v3 offset:8448
    v_exp_f32 v119, v119
    v_fma_f32 v114, v114, v17, v17
    v_fma_f32 v115, v115, v17, v17
    v_mfma_f32_32x32x16_bf16 v[96:111], v[36:39], v[228:231], v[96:111]
    ds_read_b64_tr_b16 v[36:37], v3 offset:9216
    ds_read_b64_tr_b16 v[38:39], v3 offset:9472
    v_fma_f32 v116, v116, v17, v17
    s_waitcnt lgkmcnt(13)
    v_fma_f32 v117, v117, v17, v17
    v_fma_f32 v118, v118, v17, v17
    v_mfma_f32_32x32x16_bf16 v[96:111], v[40:43], v[232:235], v[96:111]
    ds_read_b64_tr_b16 v[40:41], v3 offset:10240
    ds_read_b64_tr_b16 v[42:43], v3 offset:10496
    v_fma_f32 v119, v119, v17, v17
    v_rcp_f32 v112, v112
    v_mfma_f32_32x32x16_bf16 v[96:111], v[44:47], v[236:239], v[96:111]
    ds_read_b64_tr_b16 v[44:45], v3 offset:11264
    ds_read_b64_tr_b16 v[46:47], v3 offset:11520
    v_rcp_f32 v113, v113
    s_waitcnt lgkmcnt(13)
    v_mul_f32 v72, v72, v112
    v_mfma_f32_32x32x16_bf16 v[96:111], v[48:51], v[240:243], v[96:111]
    ds_read_b64_tr_b16 v[48:49], v3 offset:28672
    ds_read_b64_tr_b16 v[50:51], v3 offset:28928
    v_rcp_f32 v114, v114
    v_rcp_f32 v115, v115
    v_mfma_f32_32x32x16_bf16 v[96:111], v[52:55], v[244:247], v[96:111]
    ds_read_b64_tr_b16 v[52:53], v3 offset:29696
    ds_read_b64_tr_b16 v[54:55], v3 offset:29952
    v_rcp_f32 v116, v116
    s_waitcnt lgkmcnt(13)
    v_mul_f32 v73, v73, v113
    v_mfma_f32_32x32x16_bf16 v[96:111], v[56:59], v[248:251], v[96:111]
    ds_read_b64_tr_b16 v[56:57], v3 offset:30720
    ds_read_b64_tr_b16 v[58:59], v3 offset:30976
    v_rcp_f32 v117, v117
    v_rcp_f32 v118, v118
    v_mfma_f32_32x32x16_bf16 v[96:111], v[60:63], v[252:255], v[96:111]
    ds_read_b64_tr_b16 v[60:61], v3 offset:31744
    ds_read_b64_tr_b16 v[62:63], v3 offset:32000
    v_rcp_f32 v119, v119
    s_waitcnt lgkmcnt(12)
    v_mul_f32 v74, v74, v114
    v_mul_f32 v75, v75, v115
    v_mul_f32 v76, v76, v116
    v_mul_f32 v77, v77, v117
    v_mul_f32 v78, v78, v118
    v_mul_f32 v79, v79, v119
    v_mfma_f32_32x32x16_bf16 v[112:127], v[32:35], v[128:131], 0
    ds_read_b64_tr_b16 v[32:33], v3 offset:49152
    ds_read_b64_tr_b16 v[34:35], v3 offset:49408
    v_mul_f32 v96, v96, v64
    v_mul_f32 v97, v97, v65
    v_mul_f32 v98, v98, v66
    s_waitcnt lgkmcnt(10)
    v_mfma_f32_32x32x16_bf16 v[112:127], v[36:39], v[132:135], v[112:127]
    ds_read_b64_tr_b16 v[36:37], v3 offset:50176
    ds_read_b64_tr_b16 v[38:39], v3 offset:50432
    v_mul_f32 v99, v99, v67
    v_mul_f32 v100, v100, v68
    v_mul_f32 v101, v101, v69
    v_mul_f32 v102, v102, v70
    v_mfma_f32_32x32x16_bf16 v[112:127], v[40:43], v[136:139], v[112:127]
    ds_read_b64_tr_b16 v[40:41], v3 offset:51200
    ds_read_b64_tr_b16 v[42:43], v3 offset:51456
    v_mul_f32 v103, v103, v71
    v_cvt_pk_bf16_f32 v12, v96, v97
    v_cvt_pk_bf16_f32 v13, v98, v99
    s_waitcnt lgkmcnt(10)
    v_mfma_f32_32x32x16_bf16 v[112:127], v[44:47], v[140:143], v[112:127]
    ds_read_b64_tr_b16 v[44:45], v3 offset:52224
    ds_read_b64_tr_b16 v[46:47], v3 offset:52480
    v_cvt_pk_bf16_f32 v14, v100, v101
    v_cvt_pk_bf16_f32 v15, v102, v103
    v_mul_f32 v104, v104, v72
    v_mul_f32 v105, v105, v73
    v_mfma_f32_32x32x16_bf16 v[112:127], v[48:51], v[144:147], v[112:127]
    ds_read_b64_tr_b16 v[48:49], v4 offset:4096
    ds_read_b64_tr_b16 v[50:51], v4 offset:4352
    v_mul_f32 v106, v106, v74
    v_mul_f32 v107, v107, v75
    v_mul_f32 v108, v108, v76
    s_waitcnt lgkmcnt(10)
    v_mfma_f32_32x32x16_bf16 v[112:127], v[52:55], v[148:151], v[112:127]
    ds_read_b64_tr_b16 v[52:53], v4 offset:5120
    ds_read_b64_tr_b16 v[54:55], v4 offset:5376
    v_mul_f32 v109, v109, v77
    v_mul_f32 v110, v110, v78
    v_mul_f32 v111, v111, v79
    v_cvt_pk_bf16_f32 v20, v104, v105
    v_mfma_f32_32x32x16_bf16 v[112:127], v[56:59], v[152:155], v[112:127]
    ds_read_b64_tr_b16 v[56:57], v4 offset:6144
    ds_read_b64_tr_b16 v[58:59], v4 offset:6400
    v_cvt_pk_bf16_f32 v21, v106, v107
    v_cvt_pk_bf16_f32 v22, v108, v109
    v_cvt_pk_bf16_f32 v23, v110, v111
    v_mul_f32 v96, v16, v80
    v_mfma_f32_32x32x16_bf16 v[112:127], v[60:63], v[156:159], v[112:127]
    ds_read_b64_tr_b16 v[60:61], v4 offset:7168
    ds_read_b64_tr_b16 v[62:63], v4 offset:7424
    v_mov_b32 v28, 8
    ds_write_b32 v8, v28
    s_waitcnt lgkmcnt(13)
    v_mfma_f32_32x32x16_bf16 v[112:127], v[32:35], v[160:163], v[112:127]
    ds_read_b64_tr_b16 v[32:33], v4 offset:24576
    ds_read_b64_tr_b16 v[34:35], v4 offset:24832
    v_mul_f32 v97, v16, v81
    v_mul_f32 v98, v16, v82
    v_mul_f32 v99, v16, v83
    v_mul_f32 v100, v16, v84
    v_mfma_f32_32x32x16_bf16 v[112:127], v[36:39], v[164:167], v[112:127]
    ds_read_b64_tr_b16 v[36:37], v4 offset:25600
    ds_read_b64_tr_b16 v[38:39], v4 offset:25856
    v_mul_f32 v101, v16, v85
    s_waitcnt lgkmcnt(13)
    v_mul_f32 v102, v16, v86
    v_mul_f32 v103, v16, v87
    v_mfma_f32_32x32x16_bf16 v[112:127], v[40:43], v[168:171], v[112:127]
    ds_read_b64_tr_b16 v[40:41], v4 offset:26624
    ds_read_b64_tr_b16 v[42:43], v4 offset:26880
    v_exp_f32 v96, v96
    v_exp_f32 v97, v97
    v_mfma_f32_32x32x16_bf16 v[112:127], v[44:47], v[172:175], v[112:127]
    ds_read_b64_tr_b16 v[44:45], v4 offset:27648
    ds_read_b64_tr_b16 v[46:47], v4 offset:27904
    v_exp_f32 v98, v98
    s_waitcnt lgkmcnt(13)
    v_fma_f32 v96, v96, v17, v17
    v_mfma_f32_32x32x16_bf16 v[112:127], v[48:51], v[176:179], v[112:127]
    ds_read_b64_tr_b16 v[48:49], v4 offset:45056
    ds_read_b64_tr_b16 v[50:51], v4 offset:45312
    v_exp_f32 v99, v99
    v_exp_f32 v100, v100
    v_mfma_f32_32x32x16_bf16 v[112:127], v[52:55], v[180:183], v[112:127]
    ds_read_b64_tr_b16 v[52:53], v4 offset:46080
    ds_read_b64_tr_b16 v[54:55], v4 offset:46336
    v_exp_f32 v101, v101
    s_waitcnt lgkmcnt(13)
    v_fma_f32 v97, v97, v17, v17
    v_mfma_f32_32x32x16_bf16 v[112:127], v[56:59], v[184:187], v[112:127]
    ds_read_b64_tr_b16 v[56:57], v4 offset:47104
    ds_read_b64_tr_b16 v[58:59], v4 offset:47360
    v_exp_f32 v102, v102
    v_exp_f32 v103, v103
    v_mfma_f32_32x32x16_bf16 v[112:127], v[60:63], v[188:191], v[112:127]
    ds_read_b64_tr_b16 v[60:61], v4 offset:48128
    ds_read_b64_tr_b16 v[62:63], v4 offset:48384
    v_fma_f32 v98, v98, v17, v17
    s_waitcnt lgkmcnt(12)
    v_fma_f32 v99, v99, v17, v17
    v_fma_f32 v100, v100, v17, v17
    v_mfma_f32_32x32x16_bf16 v[112:127], v[32:35], v[192:195], v[112:127]
    ds_read_b64_tr_b16 v[32:33], v5 offset:0
    ds_read_b64_tr_b16 v[34:35], v5 offset:256
    v_fma_f32 v101, v101, v17, v17
    v_fma_f32 v102, v102, v17, v17
    v_fma_f32 v103, v103, v17, v17
    v_mfma_f32_32x32x16_bf16 v[112:127], v[36:39], v[196:199], v[112:127]
    ds_read_b64_tr_b16 v[36:37], v5 offset:1024
    ds_read_b64_tr_b16 v[38:39], v5 offset:1280
    v_rcp_f32 v96, v96
    s_waitcnt lgkmcnt(12)
    v_mul_f32 v80, v80, v96
    v_mfma_f32_32x32x16_bf16 v[112:127], v[40:43], v[200:203], v[112:127]
    ds_read_b64_tr_b16 v[40:41], v5 offset:2048
    ds_read_b64_tr_b16 v[42:43], v5 offset:2304
    v_rcp_f32 v97, v97
    v_rcp_f32 v98, v98
    v_mfma_f32_32x32x16_bf16 v[112:127], v[44:47], v[204:207], v[112:127]
    ds_read_b64_tr_b16 v[44:45], v5 offset:3072
    ds_read_b64_tr_b16 v[46:47], v5 offset:3328
    v_rcp_f32 v99, v99
    s_waitcnt lgkmcnt(12)
    v_mul_f32 v81, v81, v97
    v_mfma_f32_32x32x16_bf16 v[112:127], v[48:51], v[208:211], v[112:127]
    ds_read_b64_tr_b16 v[48:49], v5 offset:20480
    ds_read_b64_tr_b16 v[50:51], v5 offset:20736
    v_rcp_f32 v100, v100
    v_rcp_f32 v101, v101
    v_mfma_f32_32x32x16_bf16 v[112:127], v[52:55], v[212:215], v[112:127]
    ds_read_b64_tr_b16 v[52:53], v5 offset:21504
    ds_read_b64_tr_b16 v[54:55], v5 offset:21760
    v_rcp_f32 v102, v102
    s_waitcnt lgkmcnt(12)
    v_mul_f32 v82, v82, v98
    v_mfma_f32_32x32x16_bf16 v[112:127], v[56:59], v[216:219], v[112:127]
    ds_read_b64_tr_b16 v[56:57], v5 offset:22528
    ds_read_b64_tr_b16 v[58:59], v5 offset:22784
    v_rcp_f32 v103, v103
    v_mul_f32 v83, v83, v99
    v_mul_f32 v84, v84, v100
    v_mfma_f32_32x32x16_bf16 v[112:127], v[60:63], v[220:223], v[112:127]
    ds_read_b64_tr_b16 v[60:61], v5 offset:23552
    ds_read_b64_tr_b16 v[62:63], v5 offset:23808
    v_mov_b32 v28, 9
    ds_write_b32 v8, v28
    ds_read_b128 v[24:27], v6
    s_waitcnt lgkmcnt(14)
    v_mfma_f32_32x32x16_bf16 v[112:127], v[32:35], v[224:227], v[112:127]
    ds_read_b64_tr_b16 v[32:33], v3 offset:16384
    ds_read_b64_tr_b16 v[34:35], v3 offset:16640
    v_mul_f32 v85, v85, v101
    v_mul_f32 v86, v86, v102
    v_mul_f32 v87, v87, v103
    v_mul_f32 v96, v16, v88
    v_mfma_f32_32x32x16_bf16 v[112:127], v[36:39], v[228:231], v[112:127]
    ds_read_b64_tr_b16 v[36:37], v3 offset:17408
    ds_read_b64_tr_b16 v[38:39], v3 offset:17664
    s_waitcnt lgkmcnt(14)
    v_mul_f32 v97, v16, v89
    v_mul_f32 v98, v16, v90
    v_mul_f32 v99, v16, v91
    v_mul_f32 v100, v16, v92
    v_mfma_f32_32x32x16_bf16 v[112:127], v[40:43], v[232:235], v[112:127]
    ds_read_b64_tr_b16 v[40:41], v3 offset:18432
    ds_read_b64_tr_b16 v[42:43], v3 offset:18688
    v_mul_f32 v101, v16, v93
    v_mul_f32 v102, v16, v94
    v_mul_f32 v103, v16, v95
    v_mfma_f32_32x32x16_bf16 v[112:127], v[44:47], v[236:239], v[112:127]
    ds_read_b64_tr_b16 v[44:45], v3 offset:19456
    ds_read_b64_tr_b16 v[46:47], v3 offset:19712
    s_waitcnt lgkmcnt(14)
    v_exp_f32 v96, v96
    v_exp_f32 v97, v97
    v_mfma_f32_32x32x16_bf16 v[112:127], v[48:51], v[240:243], v[112:127]
    ds_read_b64_tr_b16 v[48:49], v3 offset:36864
    ds_read_b64_tr_b16 v[50:51], v3 offset:37120
    s_waitcnt lgkmcnt(10)
    v_min3_u32 v24, v24, v25, v26
    v_min_u32 v24, v24, v27
    v_cmp_gt_u32 vcc, 12, v24
    s_nop 0
    s_cbranch_vccnz L_o20
L_b20:
    v_mfma_f32_32x32x16_bf16 v[112:127], v[52:55], v[244:247], v[112:127]
    buffer_store_dwordx4 v[12:15], v2, s[28:31], s64 offen offset:0 sc1
    ds_read_b64_tr_b16 v[52:53], v3 offset:37888
    ds_read_b64_tr_b16 v[54:55], v3 offset:38144
    v_xor_b32 v14, 32, v10
    v_add_u32 v12, 0x10000, v10
    v_mfma_f32_32x32x16_bf16 v[112:127], v[56:59], v[248:251], v[112:127]
    ds_read_b64_tr_b16 v[56:57], v3 offset:38912
    ds_read_b64_tr_b16 v[58:59], v3 offset:39168
    v_add_u32 v15, 0x10000, v14
    v_add_u32 v13, 0x20000, v10
    v_exp_f32 v98, v98
    v_mfma_f32_32x32x16_bf16 v[112:127], v[60:63], v[252:255], v[112:127]
    buffer_store_dwordx4 v[20:23], v2, s[28:31], s64 offen offset:1024 sc1
    ds_read_b64_tr_b16 v[60:61], v3 offset:39936
    ds_read_b64_tr_b16 v[62:63], v3 offset:40192
    s_waitcnt lgkmcnt(12)
    v_add_u32 v20, 0x20000, v14
    v_fma_f32 v96, v96, v17, v17
    v_mfma_f32_32x32x16_bf16 v[64:79], v[32:35], v[128:131], 0
    ds_read_b64_tr_b16 v[32:33], v3 offset:57344
    ds_read_b64_tr_b16 v[34:35], v3 offset:57600
    v_exp_f32 v99, v99
    v_exp_f32 v100, v100
    v_mfma_f32_32x32x16_bf16 v[64:79], v[36:39], v[132:135], v[64:79]
    ds_read_b64_tr_b16 v[36:37], v3 offset:58368
    ds_read_b64_tr_b16 v[38:39], v3 offset:58624
    s_waitcnt lgkmcnt(12)
    v_exp_f32 v101, v101
    v_exp_f32 v102, v102
    v_mfma_f32_32x32x16_bf16 v[64:79], v[40:43], v[136:139], v[64:79]
    ds_read_b64_tr_b16 v[40:41], v3 offset:59392
    ds_read_b64_tr_b16 v[42:43], v3 offset:59648
    v_exp_f32 v103, v103
    v_fma_f32 v97, v97, v17, v17
    v_fma_f32 v98, v98, v17, v17
    v_mfma_f32_32x32x16_bf16 v[64:79], v[44:47], v[140:143], v[64:79]
    ds_read_b64_tr_b16 v[44:45], v3 offset:60416
    ds_read_b64_tr_b16 v[46:47], v3 offset:60672
    v_fma_f32 v99, v99, v17, v17
    v_fma_f32 v100, v100, v17, v17
    s_waitcnt lgkmcnt(12)
    v_fma_f32 v101, v101, v17, v17
    v_mfma_f32_32x32x16_bf16 v[64:79], v[48:51], v[144:147], v[64:79]
    ds_read_b64_tr_b16 v[48:49], v4 offset:12288
    ds_read_b64_tr_b16 v[50:51], v4 offset:12544
    v_fma_f32 v102, v102, v17, v17
    v_fma_f32 v103, v103, v17, v17
    v_rcp_f32 v96, v96
    v_mfma_f32_32x32x16_bf16 v[64:79], v[52:55], v[148:151], v[64:79]
    ds_read_b64_tr_b16 v[52:53], v4 offset:13312
    ds_read_b64_tr_b16 v[54:55], v4 offset:13568
    v_rcp_f32 v97, v97
    s_waitcnt lgkmcnt(12)
    v_mul_f32 v88, v88, v96
    v_mfma_f32_32x32x16_bf16 v[64:79], v[56:59], v[152:155], v[64:79]
    ds_read_b64_tr_b16 v[56:57], v4 offset:14336
    ds_read_b64_tr_b16 v[58:59], v4 offset:14592
    v_rcp_f32 v98, v98
    v_rcp_f32 v99, v99
    v_mfma_f32_32x32x16_bf16 v[64:79], v[60:63], v[156:159], v[64:79]
    ds_read_b64_tr_b16 v[60:61], v4 offset:15360
    ds_read_b64_tr_b16 v[62:63], v4 offset:15616
    v_mov_b32 v28, 10
    ds_write_b32 v8, v28
    s_waitcnt lgkmcnt(13)
    v_mfma_f32_32x32x16_bf16 v[64:79], v[32:35], v[160:163], v[64:79]
    ds_read_b64_tr_b16 v[32:33], v4 offset:32768
    ds_read_b64_tr_b16 v[34:35], v4 offset:33024
    v_rcp_f32 v100, v100
    v_rcp_f32 v101, v101
    v_mfma_f32_32x32x16_bf16 v[64:79], v[36:39], v[164:167], v[64:79]
    ds_read_b64_tr_b16 v[36:37], v4 offset:33792
    ds_read_b64_tr_b16 v[38:39], v4 offset:34048
    v_rcp_f32 v102, v102
    s_waitcnt lgkmcnt(13)
    v_mul_f32 v89, v89, v97
    v_mfma_f32_32x32x16_bf16 v[64:79], v[40:43], v[168:171], v[64:79]
    ds_read_b64_tr_b16 v[40:41], v4 offset:34816
    ds_read_b64_tr_b16 v[42:43], v4 offset:35072
    v_rcp_f32 v103, v103
    v_mul_f32 v90, v90, v98
    v_mul_f32 v91, v91, v99
    v_mfma_f32_32x32x16_bf16 v[64:79], v[44:47], v[172:175], v[64:79]
    ds_read_b64_tr_b16 v[44:45], v4 offset:35840
    ds_read_b64_tr_b16 v[46:47], v4 offset:36096
    v_mul_f32 v92, v92, v100
    s_waitcnt lgkmcnt(13)
    v_mul_f32 v93, v93, v101
    v_mul_f32 v94, v94, v102
    v_mfma_f32_32x32x16_bf16 v[64:79], v[48:51], v[176:179], v[64:79]
    ds_read_b64_tr_b16 v[48:49], v4 offset:53248
    ds_read_b64_tr_b16 v[50:51], v4 offset:53504
    v_mul_f32 v95, v95, v103
    v_mul_f32 v104, v16, v112
    v_mul_f32 v105, v16, v113
    v_mul_f32 v106, v16, v114
    v_mfma_f32_32x32x16_bf16 v[64:79], v[52:55], v[180:183], v[64:79]
    ds_read_b64_tr_b16 v[52:53], v4 offset:54272
    ds_read_b64_tr_b16 v[54:55], v4 offset:54528
    v_mul_f32 v107, v16, v115
    s_waitcnt lgkmcnt(13)
    buffer_load_dword v31, v18, s[28:31], s5 offen sc1
    v_mfma_f32_32x32x16_bf16 v[64:79], v[56:59], v[184:187], v[64:79]
    ds_read_b64_tr_b16 v[56:57], v4 offset:55296
    ds_read_b64_tr_b16 v[58:59], v4 offset:55552
    v_mul_f32 v108, v16, v116
    v_exp_f32 v104, v104
    v_mul_f32 v21, v16, v117
    v_mfma_f32_32x32x16_bf16 v[64:79], v[60:63], v[188:191], v[64:79]
    ds_read_b64_tr_b16 v[60:61], v4 offset:56320
    ds_read_b64_tr_b16 v[62:63], v4 offset:56576
    v_exp_f32 v105, v105
    s_waitcnt lgkmcnt(12)
    v_fma_f32 v104, v104, v17, v17
    v_mfma_f32_32x32x16_bf16 v[64:79], v[32:35], v[192:195], v[64:79]
    ds_read_b64_tr_b16 v[32:33], v5 offset:8192
    ds_read_b64_tr_b16 v[34:35], v5 offset:8448
    v_exp_f32 v106, v106
    v_exp_f32 v107, v107
    v_mfma_f32_32x32x16_bf16 v[64:79], v[36:39], v[196:199], v[64:79]
    ds_read_b64_tr_b16 v[36:37], v5 offset:9216
    ds_read_b64_tr_b16 v[38:39], v5 offset:9472
    v_exp_f32 v108, v108
    s_waitcnt lgkmcnt(12)
    v_fma_f32 v105, v105, v17, v17
    v_mfma_f32_32x32x16_bf16 v[64:79], v[40:43], v[200:203], v[64:79]
    ds_read_b64_tr_b16 v[40:41], v5 offset:10240
    ds_read_b64_tr_b16 v[42:43], v5 offset:10496
    v_fma_f32 v106, v106, v17, v17
    v_fma_f32 v107, v107, v17, v17
    v_fma_f32 v108, v108, v17, v17
    v_mul_f32 v22, v16, v118
    v_mfma_f32_32x32x16_bf16 v[64:79], v[44:47], v[204:207], v[64:79]
    ds_read_b64_tr_b16 v[44:45], v5 offset:11264
    ds_read_b64_tr_b16 v[46:47], v5 offset:11520
    v_rcp_f32 v104, v104
    s_waitcnt lgkmcnt(12)
    v_mul_f32 v112, v112, v104
    v_mfma_f32_32x32x16_bf16 v[64:79], v[48:51], v[208:211], v[64:79]
    ds_read_b64_tr_b16 v[48:49], v3 offset:0
    ds_read_b64_tr_b16 v[50:51], v3 offset:256
    v_rcp_f32 v105, v105
    v_rcp_f32 v106, v106
    v_mfma_f32_32x32x16_bf16 v[64:79], v[52:55], v[212:215], v[64:79]
    ds_read_b64_tr_b16 v[52:53], v3 offset:1024
    ds_read_b64_tr_b16 v[54:55], v3 offset:1280
    v_rcp_f32 v107, v107
    s_waitcnt lgkmcnt(12)
    v_mul_f32 v113, v113, v105
    v_mfma_f32_32x32x16_bf16 v[64:79], v[56:59], v[216:219], v[64:79]
    ds_read_b64_tr_b16 v[56:57], v3 offset:2048
    ds_read_b64_tr_b16 v[58:59], v3 offset:2304
    v_rcp_f32 v108, v108
    v_mul_f32 v114, v114, v106
    v_mul_f32 v115, v115, v107
    v_mfma_f32_32x32x16_bf16 v[64:79], v[60:63], v[220:223], v[64:79]
    ds_read_b64_tr_b16 v[60:61], v3 offset:3072
    ds_read_b64_tr_b16 v[62:63], v3 offset:3328
    v_mov_b32 v28, 11
    ds_write_b32 v8, v28
    s_waitcnt lgkmcnt(13)
    v_mfma_f32_32x32x16_bf16 v[64:79], v[32:35], v[224:227], v[64:79]
    ds_read_b64_tr_b16 v[32:33], v3 offset:4096
    ds_read_b64_tr_b16 v[34:35], v3 offset:4352
    v_mul_f32 v116, v116, v108
    v_mul_f32 v23, v16, v119
    v_exp_f32 v21, v21
    v_mfma_f32_32x32x16_bf16 v[64:79], v[36:39], v[228:231], v[64:79]
    ds_read_b64_tr_b16 v[36:37], v3 offset:5120
    ds_read_b64_tr_b16 v[38:39], v3 offset:5376
    v_exp_f32 v22, v22
    s_waitcnt lgkmcnt(13)
    v_fma_f32 v21, v21, v17, v17
    v_mfma_f32_32x32x16_bf16 v[64:79], v[40:43], v[232:235], v[64:79]
    ds_read_b64_tr_b16 v[40:41], v3 offset:6144
    ds_read_b64_tr_b16 v[42:43], v3 offset:6400
    v_exp_f32 v23, v23
    v_fma_f32 v22, v22, v17, v17
    v_fma_f32 v23, v23, v17, v17
    v_mfma_f32_32x32x16_bf16 v[64:79], v[44:47], v[236:239], v[64:79]
    ds_read_b64_tr_b16 v[44:45], v3 offset:7168
    ds_read_b64_tr_b16 v[46:47], v3 offset:7424
    v_rcp_f32 v21, v21
    s_waitcnt lgkmcnt(13)
    v_mul_f32 v117, v117, v21
    v_mfma_f32_32x32x16_bf16 v[64:79], v[48:51], v[240:243], v[64:79]
    ds_read_b64_tr_b16 v[48:49], v3 offset:20480
    ds_read_b64_tr_b16 v[50:51], v3 offset:20736
    v_rcp_f32 v22, v22
    v_rcp_f32 v23, v23
    v_mfma_f32_32x32x16_bf16 v[64:79], v[52:55], v[244:247], v[64:79]
    ds_read_b64_tr_b16 v[52:53], v3 offset:21504
    ds_read_b64_tr_b16 v[54:55], v3 offset:21760
    v_mul_f32 v118, v118, v22
    s_waitcnt lgkmcnt(13)
    v_mul_f32 v119, v119, v23
    v_mul_f32 v30, v16, v120
    v_mfma_f32_32x32x16_bf16 v[64:79], v[56:59], v[248:251], v[64:79]
    ds_read_b64_tr_b16 v[56:57], v3 offset:22528
    ds_read_b64_tr_b16 v[58:59], v3 offset:22784
    v_mul_f32 v21, v16, v121
    v_mul_f32 v22, v16, v122
    v_mul_f32 v23, v16, v123
    v_mfma_f32_32x32x16_bf16 v[64:79], v[60:63], v[252:255], v[64:79]
    ds_read_b64_tr_b16 v[60:61], v3 offset:23552
    ds_read_b64_tr_b16 v[62:63], v3 offset:23808
    v_exp_f32 v30, v30
    s_waitcnt lgkmcnt(12)
    v_fma_f32 v30, v30, v17, v17
    v_mfma_f32_32x32x16_bf16 v[96:111], v[32:35], v[128:131], 0
    ds_read_b64_tr_b16 v[32:33], v3 offset:24576
    ds_read_b64_tr_b16 v[34:35], v3 offset:24832
    v_exp_f32 v21, v21
    v_exp_f32 v22, v22
    v_mfma_f32_32x32x16_bf16 v[96:111], v[36:39], v[132:135], v[96:111]
    ds_read_b64_tr_b16 v[36:37], v3 offset:25600
    ds_read_b64_tr_b16 v[38:39], v3 offset:25856
    v_mul_f32 v64, v64, v80
    s_waitcnt lgkmcnt(12)
    v_mul_f32 v65, v65, v81
    v_mul_f32 v66, v66, v82
    v_mfma_f32_32x32x16_bf16 v[96:111], v[40:43], v[136:139], v[96:111]
    ds_read_b64_tr_b16 v[40:41], v3 offset:26624
    ds_read_b64_tr_b16 v[42:43], v3 offset:26880
    v_mul_f32 v67, v67, v83
    v_mul_f32 v68, v68, v84
    v_mul_f32 v69, v69, v85
    v_mul_f32 v70, v70, v86
    v_mfma_f32_32x32x16_bf16 v[96:111], v[44:47], v[140:143], v[96:111]
    ds_read_b64_tr_b16 v[44:45], v3 offset:27648
    ds_read_b64_tr_b16 v[46:47], v3 offset:27904
    v_mul_f32 v71, v71, v87
    s_waitcnt lgkmcnt(12)
    s_waitcnt vmcnt(0)
    v_cmp_ne_u32 vcc, s33, v31
    s_nop 0
    s_cbranch_vccnz L_o21
L_b21:
    v_mfma_f32_32x32x16_bf16 v[96:111], v[48:51], v[144:147], v[96:111]
    ds_read_b64_tr_b16 v[48:49], v3 offset:40960
    ds_read_b64_tr_b16 v[50:51], v3 offset:41216
    v_cvt_pk_bf16_f32 v80, v64, v65
    v_cvt_pk_bf16_f32 v81, v66, v67
    v_cvt_pk_bf16_f32 v82, v68, v69
    v_cvt_pk_bf16_f32 v83, v70, v71
    v_mfma_f32_32x32x16_bf16 v[96:111], v[52:55], v[148:151], v[96:111]
    buffer_store_dwordx4 v[80:83], v2, s[28:31], s37 offen offset:0 sc1
    ds_read_b64_tr_b16 v[52:53], v3 offset:41984
    ds_read_b64_tr_b16 v[54:55], v3 offset:42240
    s_waitcnt lgkmcnt(12)
    v_mul_f32 v72, v72, v88
    v_mul_f32 v73, v73, v89
    v_mfma_f32_32x32x16_bf16 v[96:111], v[56:59], v[152:155], v[96:111]
    ds_read_b64_tr_b16 v[56:57], v3 offset:43008
    ds_read_b64_tr_b16 v[58:59], v3 offset:43264
    v_mul_f32 v74, v74, v90
    v_mul_f32 v75, v75, v91
    v_mul_f32 v76, v76, v92
    v_mul_f32 v77, v77, v93
    v_mfma_f32_32x32x16_bf16 v[96:111], v[60:63], v[156:159], v[96:111]
    ds_read_b64_tr_b16 v[60:61], v3 offset:44032
    ds_read_b64_tr_b16 v[62:63], v3 offset:44288
    v_mov_b32 v28, 12
    ds_write_b32 v8, v28
    s_add_u32 s78, s42, 0x0
    buffer_load_dwordx4 v[128:131], v2, s[28:31], s78 offen offset:0 sc1
    s_waitcnt lgkmcnt(13)
    v_mfma_f32_32x32x16_bf16 v[96:111], v[32:35], v[160:163], v[96:111]
    ds_read_b64_tr_b16 v[32:33], v3 offset:45056
    ds_read_b64_tr_b16 v[34:35], v3 offset:45312
    v_mul_f32 v78, v78, v94
    v_mul_f32 v79, v79, v95
    v_cvt_pk_bf16_f32 v88, v72, v73
    v_cvt_pk_bf16_f32 v89, v74, v75
    v_mfma_f32_32x32x16_bf16 v[96:111], v[36:39], v[164:167], v[96:111]
    ds_read_b64_tr_b16 v[36:37], v3 offset:46080
    ds_read_b64_tr_b16 v[38:39], v3 offset:46336
    s_waitcnt lgkmcnt(13)
    v_cvt_pk_bf16_f32 v90, v76, v77
    v_cvt_pk_bf16_f32 v91, v78, v79
    buffer_store_dwordx4 v[88:91], v2, s[28:31], s37 offen offset:1024 sc1
    v_mfma_f32_32x32x16_bf16 v[96:111], v[40:43], v[168:171], v[96:111]
    ds_read_b64_tr_b16 v[40:41], v3 offset:47104
    ds_read_b64_tr_b16 v[42:43], v3 offset:47360
    v_exp_f32 v23, v23
    v_fma_f32 v21, v21, v17, v17
    v_fma_f32 v22, v22, v17, v17
    v_mfma_f32_32x32x16_bf16 v[96:111], v[44:47], v[172:175], v[96:111]
    ds_read_b64_tr_b16 v[44:45], v3 offset:48128
    ds_read_b64_tr_b16 v[46:47], v3 offset:48384
    ds_read_b128 v[24:27], v6
    s_waitcnt lgkmcnt(14)
    buffer_load_dwordx4 v[132:135], v2, s[28:31], s78 offen offset:2048 sc1
    v_fma_f32 v23, v23, v17, v17
    v_mfma_f32_32x32x16_bf16 v[96:111], v[48:51], v[176:179], v[96:111]
    ds_read_b64_tr_b16 v[48:49], v3 offset:61440
    ds_read_b64_tr_b16 v[50:51], v3 offset:61696
    v_rcp_f32 v30, v30
    v_rcp_f32 v21, v21
    v_mfma_f32_32x32x16_bf16 v[96:111], v[52:55], v[180:183], v[96:111]
    ds_read_b64_tr_b16 v[52:53], v3 offset:62464
    ds_read_b64_tr_b16 v[54:55], v3 offset:62720
    s_waitcnt lgkmcnt(14)
    v_rcp_f32 v22, v22
    s_add_u32 s78, s42, 0x1000
    buffer_load_dwordx4 v[136:139], v2, s[28:31], s78 offen offset:0 sc1
    v_mfma_f32_32x32x16_bf16 v[96:111], v[56:59], v[184:187], v[96:111]
    ds_read_b64_tr_b16 v[56:57], v3 offset:63488
    ds_read_b64_tr_b16 v[58:59], v3 offset:63744
    v_rcp_f32 v23, v23
    v_mul_f32 v120, v120, v30
    v_mul_f32 v121, v121, v21
    v_mfma_f32_32x32x16_bf16 v[96:111], v[60:63], v[188:191], v[96:111]
    ds_read_b64_tr_b16 v[60:61], v3 offset:64512
    ds_read_b64_tr_b16 v[62:63], v3 offset:64768
    s_waitcnt lgkmcnt(13)
    s_waitcnt lgkmcnt(8)
    v_min3_u32 v24, v24, v25, v26
    v_min_u32 v24, v24, v27
    v_cmp_gt_u32 vcc, 14, v24
    s_nop 0
    s_cbranch_vccnz L_o22
L_b22:
    buffer_load_dwordx4 v[140:143], v2, s[28:31], s78 offen offset:2048 sc1
    v_mfma_f32_32x32x16_bf16 v[96:111], v[32:35], v[192:195], v[96:111]
    ds_read_b64_tr_b16 v[32:33], v4 offset:0
    ds_read_b64_tr_b16 v[34:35], v4 offset:256
    v_mul_f32 v122, v122, v22
    v_mul_f32 v123, v123, v23
    v_mul_f32 v30, v16, v124
    v_mul_f32 v21, v16, v125
    v_mfma_f32_32x32x16_bf16 v[96:111], v[36:39], v[196:199], v[96:111]
    ds_read_b64_tr_b16 v[36:37], v4 offset:1024
    ds_read_b64_tr_b16 v[38:39], v4 offset:1280
    v_mul_f32 v22, v16, v126
    v_mul_f32 v23, v16, v127
    s_add_u32 s78, s43, 0x0
    buffer_load_dwordx4 v[144:147], v2, s[28:31], s78 offen offset:0 sc1
    v_mfma_f32_32x32x16_bf16 v[96:111], v[40:43], v[200:203], v[96:111]
    ds_read_b64_tr_b16 v[40:41], v4 offset:2048
    ds_read_b64_tr_b16 v[42:43], v4 offset:2304
    v_exp_f32 v30, v30
    v_exp_f32 v21, v21
    v_mfma_f32_32x32x16_bf16 v[96:111], v[44:47], v[204:207], v[96:111]
    ds_read_b64_tr_b16 v[44:45], v4 offset:3072
    ds_read_b64_tr_b16 v[46:47], v4 offset:3328
    s_waitcnt lgkmcnt(12)
    v_exp_f32 v22, v22
    v_exp_f32 v23, v23
    v_mfma_f32_32x32x16_bf16 v[96:111], v[48:51], v[208:211], v[96:111]
    buffer_load_dwordx4 v[148:151], v2, s[28:31], s78 offen offset:2048 sc1
    ds_read_b64_tr_b16 v[48:49], v4 offset:16384
    ds_read_b64_tr_b16 v[50:51], v4 offset:16640
    v_fma_f32 v30, v30, v17, v17
    v_fma_f32 v21, v21, v17, v17
    v_fma_f32 v22, v22, v17, v17
    v_mfma_f32_32x32x16_bf16 v[96:111], v[52:55], v[212:215], v[96:111]
    ds_read_b64_tr_b16 v[52:53], v4 offset:17408
    ds_read_b64_tr_b16 v[54:55], v4 offset:17664
    s_waitcnt lgkmcnt(12)
    v_fma_f32 v23, v23, v17, v17
    v_rcp_f32 v30, v30
    v_mfma_f32_32x32x16_bf16 v[96:111], v[56:59], v[216:219], v[96:111]
    ds_read_b64_tr_b16 v[56:57], v4 offset:18432
    s_add_u32 s78, s43, 0x1000
    buffer_load_dwordx4 v[152:155], v2, s[28:31], s78 offen offset:0 sc1
    ds_read_b64_tr_b16 v[58:59], v4 offset:18688
    v_rcp_f32 v21, v21
    v_mfma_f32_32x32x16_bf16 v[96:111], v[60:63], v[220:223], v[96:111]
    ds_read_b64_tr_b16 v[60:61], v4 offset:19456
    ds_read_b64_tr_b16 v[62:63], v4 offset:19712
    s_waitcnt lgkmcnt(12)
    v_rcp_f32 v22, v22
    v_rcp_f32 v23, v23
    v_mfma_f32_32x32x16_bf16 v[96:111], v[32:35], v[224:227], v[96:111]
    ds_read_b64_tr_b16 v[32:33], v12 offset:20480
    ds_read_b64_tr_b16 v[34:35], v12 offset:20992
    v_mul_f32 v124, v124, v30
    buffer_load_dwordx4 v[156:159], v2, s[28:31], s78 offen offset:2048 sc1
    v_mfma_f32_32x32x16_bf16 v[96:111], v[36:39], v[228:231], v[96:111]
    ds_read_b64_tr_b16 v[36:37], v15 offset:20480
    ds_read_b64_tr_b16 v[38:39], v15 offset:20992
    v_mul_f32 v125, v125, v21
    s_waitcnt lgkmcnt(12)
    v_mul_f32 v126, v126, v22
    v_mul_f32 v127, v127, v23
    v_mfma_f32_32x32x16_bf16 v[96:111], v[40:43], v[232:235], v[96:111]
    ds_read_b64_tr_b16 v[40:41], v12 offset:36864
    ds_read_b64_tr_b16 v[42:43], v12 offset:37376
    s_lshl_b32 s62, s48, 3
    s_lshr_b32 s62, 0x324231f, s62
    s_and_b32 s62, s62, 0xff
    s_lshl_b32 s62, s62, 12
    v_add_u32 v22, s62, v2
    v_mfma_f32_32x32x16_bf16 v[96:111], v[44:47], v[236:239], v[96:111]
    s_add_u32 s78, s44, 0x0
    buffer_load_dwordx4 v[160:163], v2, s[28:31], s78 offen offset:0 sc1
    ds_read_b64_tr_b16 v[44:45], v15 offset:36864
    ds_read_b64_tr_b16 v[46:47], v15 offset:37376
    s_waitcnt lgkmcnt(12)
    v_and_b32 v21, 31, v1
    v_and_b32 v19, 7, v21
    v_mfma_f32_32x32x16_bf16 v[96:111], v[48:51], v[240:243], v[96:111]
    ds_read_b64_tr_b16 v[48:49], v12 offset:40960
    ds_read_b64_tr_b16 v[50:51], v12 offset:41472
    s_lshl_b32 s62, s74, 1
    v_add_u32 v9, s62, v9
    v_xor_b32 v9, v9, v19
    v_lshl_add_u32 v21, v21, 7, s7
    v_mfma_f32_32x32x16_bf16 v[96:111], v[52:55], v[244:247], v[96:111]
    ds_read_b64_tr_b16 v[52:53], v15 offset:40960
    ds_read_b64_tr_b16 v[54:55], v15 offset:41472
    s_xor_b32 s62, s48, 2
    s_lshl_b32 s62, s62, 3
    s_lshr_b32 s62, 0x324231f, s62
    s_and_b32 s62, s62, 0xff
    s_lshl_b32 s62, s62, 12
    v_add_u32 v23, s62, v2
    s_waitcnt lgkmcnt(12)
    buffer_load_dwordx4 v[164:167], v2, s[28:31], s78 offen offset:2048 sc1
    v_mfma_f32_32x32x16_bf16 v[96:111], v[56:59], v[248:251], v[96:111]
    ds_read_b64_tr_b16 v[56:57], v12 offset:57344
    ds_read_b64_tr_b16 v[58:59], v12 offset:57856
    v_mfma_f32_32x32x16_bf16 v[96:111], v[60:63], v[252:255], v[96:111]
    ds_read_b64_tr_b16 v[60:61], v15 offset:57344
    ds_read_b64_tr_b16 v[62:63], v15 offset:57856
    v_mov_b32 v28, 13
    ds_write_b32 v8, v28
    s_add_u32 s78, s44, 0x1000
    buffer_load_dwordx4 v[168:171], v2, s[28:31], s78 offen offset:0 sc1
    s_nop 5
    v_mul_f32 v96, v96, v112
    v_mul_f32 v97, v97, v113
    v_mul_f32 v98, v98, v114
    v_mul_f32 v99, v99, v115
    v_mul_f32 v100, v100, v116
    v_mul_f32 v101, v101, v117
    v_mul_f32 v102, v102, v118
    v_mul_f32 v103, v103, v119
    v_cvt_pk_bf16_f32 v112, v96, v97
    v_cvt_pk_bf16_f32 v113, v98, v99
    v_cvt_pk_bf16_f32 v114, v100, v101
    v_cvt_pk_bf16_f32 v115, v102, v103
    v_mul_f32 v104, v104, v120
    v_mul_f32 v105, v105, v121
    v_mul_f32 v106, v106, v122
    v_mul_f32 v107, v107, v123
    v_mul_f32 v108, v108, v124
    v_mul_f32 v109, v109, v125
    v_mul_f32 v110, v110, v126
    v_mul_f32 v111, v111, v127
    v_cvt_pk_bf16_f32 v120, v104, v105
    v_cvt_pk_bf16_f32 v121, v106, v107
    v_cvt_pk_bf16_f32 v122, v108, v109
    v_cvt_pk_bf16_f32 v123, v110, v111
    buffer_store_dwordx4 v[112:115], v2, s[28:31], s3 offen offset:0 sc1
    buffer_store_dwordx4 v[120:123], v2, s[28:31], s3 offen offset:1024 sc1
    s_nop 0
    buffer_load_dwordx4 v[112:115], v11, s[28:31], s82 offen sc1
    s_waitcnt vmcnt(11)
    v_max3_u32 v29, v128, v132, v136
    buffer_load_dwordx4 v[116:119], v11, s[28:31], s82 offen offset:512 sc1
    s_waitcnt vmcnt(11)
    v_max_u32 v29, v29, v140
    v_cmp_eq_u32 vcc, -1, v29
    s_nop 0
    s_cbranch_vccnz L_o23
L_b23:
    s_waitcnt lgkmcnt(13)
    v_mfma_f32_32x32x16_bf16 v[64:79], v[32:35], v[128:131], 0
    buffer_load_dword v120, v7, s[28:31], s6 offen sc1
    ds_read_b64_tr_b16 v[32:33], v12 offset:61440
    ds_read_b64_tr_b16 v[34:35], v12 offset:61952
    s_waitcnt lgkmcnt(11)
    s_waitcnt lgkmcnt(7)
    s_waitcnt lgkmcnt(3)
    v_mfma_f32_32x32x16_bf16 v[80:95], v[36:39], v[128:131], 0
    ds_read_b64_tr_b16 v[36:37], v15 offset:61440
    ds_read_b64_tr_b16 v[38:39], v15 offset:61952
    v_mfma_f32_32x32x16_bf16 v[64:79], v[40:43], v[132:135], v[64:79]
    buffer_load_dwordx4 v[172:175], v2, s[28:31], s78 offen offset:2048 sc1
    ds_read_b64_tr_b16 v[40:41], v13 offset:12288
    ds_read_b64_tr_b16 v[42:43], v13 offset:12800
    v_mfma_f32_32x32x16_bf16 v[80:95], v[44:47], v[132:135], v[80:95]
    ds_read_b64_tr_b16 v[44:45], v20 offset:12288
    ds_read_b64_tr_b16 v[46:47], v20 offset:12800
    v_mfma_f32_32x32x16_bf16 v[64:79], v[48:51], v[136:139], v[64:79]
    ds_read_b64_tr_b16 v[48:49], v13 offset:16384
    s_add_u32 s78, s45, 0x0
    buffer_load_dwordx4 v[176:179], v2, s[28:31], s78 offen offset:0 sc1
    ds_read_b64_tr_b16 v[50:51], v13 offset:16896
    v_mfma_f32_32x32x16_bf16 v[80:95], v[52:55], v[136:139], v[80:95]
    ds_read_b64_tr_b16 v[52:53], v20 offset:16384
    ds_read_b64_tr_b16 v[54:55], v20 offset:16896
    s_waitcnt vmcnt(11)
    v_max3_u32 v29, v144, v148, v152
    v_mfma_f32_32x32x16_bf16 v[64:79], v[56:59], v[140:143], v[64:79]
    ds_read_b64_tr_b16 v[56:57], v10 offset:12288
    ds_read_b64_tr_b16 v[58:59], v10 offset:12800
    buffer_load_dwordx4 v[180:183], v2, s[28:31], s78 offen offset:2048 sc1
    v_mfma_f32_32x32x16_bf16 v[80:95], v[60:63], v[140:143], v[80:95]
    ds_read_b64_tr_b16 v[60:61], v14 offset:12288
    ds_read_b64_tr_b16 v[62:63], v14 offset:12800
    ds_read_b128 v[24:27], v6
    s_waitcnt vmcnt(11)
    v_max_u32 v29, v29, v156
    v_cmp_eq_u32 vcc, -1, v29
    s_nop 0
    s_cbranch_vccnz L_o24
L_b24:
    s_add_u32 s78, s45, 0x1000
    buffer_load_dwordx4 v[184:187], v2, s[28:31], s78 offen offset:0 sc1
    s_waitcnt lgkmcnt(13)
    v_mfma_f32_32x32x16_bf16 v[64:79], v[32:35], v[144:147], v[64:79]
    ds_read_b64_tr_b16 v[32:33], v10 offset:32768
    ds_read_b64_tr_b16 v[34:35], v10 offset:33280
    s_waitcnt lgkmcnt(11)
    v_mfma_f32_32x32x16_bf16 v[80:95], v[36:39], v[144:147], v[80:95]
    ds_read_b64_tr_b16 v[36:37], v14 offset:32768
    ds_read_b64_tr_b16 v[38:39], v14 offset:33280
    buffer_load_dwordx4 v[188:191], v2, s[28:31], s78 offen offset:2048 sc1
    v_mfma_f32_32x32x16_bf16 v[64:79], v[40:43], v[148:151], v[64:79]
    ds_read_b64_tr_b16 v[40:41], v10 offset:53248
    ds_read_b64_tr_b16 v[42:43], v10 offset:53760
    s_waitcnt lgkmcnt(11)
    s_waitcnt lgkmcnt(6)
    v_min3_u32 v24, v24, v25, v26
    v_min_u32 v24, v24, v27
    v_cmp_gt_u32 vcc, 16, v24
    s_nop 0
    s_cbranch_vccnz L_o25
L_b25:
    v_mfma_f32_32x32x16_bf16 v[80:95], v[44:47], v[148:151], v[80:95]
    ds_read_b64_tr_b16 v[44:45], v14 offset:53248
    ds_read_b64_tr_b16 v[46:47], v14 offset:53760
    s_add_u32 s78, s42, 0x8000
    buffer_load_dwordx4 v[192:195], v2, s[28:31], s78 offen offset:0 sc1
    v_mfma_f32_32x32x16_bf16 v[64:79], v[48:51], v[152:155], v[64:79]
    ds_read_b64_tr_b16 v[48:49], v12 offset:8192
    ds_read_b64_tr_b16 v[50:51], v12 offset:8704
    v_mfma_f32_32x32x16_bf16 v[80:95], v[52:55], v[152:155], v[80:95]
    ds_read_b64_tr_b16 v[52:53], v15 offset:8192
    ds_read_b64_tr_b16 v[54:55], v15 offset:8704
    buffer_load_dwordx4 v[196:199], v2, s[28:31], s78 offen offset:2048 sc1
    v_mfma_f32_32x32x16_bf16 v[64:79], v[56:59], v[156:159], v[64:79]
    ds_read_b64_tr_b16 v[56:57], v12 offset:28672
    ds_read_b64_tr_b16 v[58:59], v12 offset:29184
    s_waitcnt vmcnt(12)
    v_max3_u32 v29, v160, v164, v168
    v_mfma_f32_32x32x16_bf16 v[80:95], v[60:63], v[156:159], v[80:95]
    ds_read_b64_tr_b16 v[60:61], v15 offset:28672
    ds_read_b64_tr_b16 v[62:63], v15 offset:29184
    s_add_u32 s78, s42, 0x9000
    buffer_load_dwordx4 v[200:203], v2, s[28:31], s78 offen offset:0 sc1
    buffer_load_dwordx4 v[204:207], v2, s[28:31], s78 offen offset:2048 sc1
    s_add_u32 s78, s43, 0x8000
    buffer_load_dwordx4 v[208:211], v2, s[28:31], s78 offen offset:0 sc1
    buffer_load_dwordx4 v[212:215], v2, s[28:31], s78 offen offset:2048 sc1
    s_add_u32 s78, s43, 0x9000
    buffer_load_dwordx4 v[216:219], v2, s[28:31], s78 offen offset:0 sc1
    s_waitcnt vmcnt(12)
    v_max3_u32 v30, v112, v116, v120
    v_cmp_eq_u32 vcc, -1, v30
    s_nop 0
    s_cbranch_vccnz L_o37
L_b37:
    buffer_load_dwordx4 v[220:223], v2, s[28:31], s78 offen offset:2048 sc1
    v_lshlrev_b32 v96, 16, v112
    v_and_b32 v97, 0xffff0000, v112
    v_lshlrev_b32 v98, 16, v113
    v_and_b32 v99, 0xffff0000, v113
    v_lshlrev_b32 v100, 16, v116
    v_and_b32 v101, 0xffff0000, v116
    v_lshlrev_b32 v102, 16, v117
    v_and_b32 v103, 0xffff0000, v117
    v_lshlrev_b32 v104, 16, v114
    v_and_b32 v105, 0xffff0000, v114
    s_waitcnt vmcnt(12)
    v_max_u32 v29, v29, v172
    v_cmp_eq_u32 vcc, -1, v29
    s_nop 0
    s_cbranch_vccnz L_o26
L_b26:
    v_lshlrev_b32 v106, 16, v115
    s_waitcnt lgkmcnt(12)
    s_add_u32 s78, s44, 0x8000
    buffer_load_dwordx4 v[224:227], v2, s[28:31], s78 offen offset:0 sc1
    v_mfma_f32_32x32x16_bf16 v[64:79], v[32:35], v[160:163], v[64:79]
    ds_read_b64_tr_b16 v[32:33], v12 offset:49152
    ds_read_b64_tr_b16 v[34:35], v12 offset:49664
    s_waitcnt lgkmcnt(10)
    s_waitcnt lgkmcnt(6)
    s_waitcnt lgkmcnt(2)
    v_and_b32 v107, 0xffff0000, v115
    v_lshlrev_b32 v108, 16, v118
    v_mfma_f32_32x32x16_bf16 v[80:95], v[36:39], v[160:163], v[80:95]
    ds_read_b64_tr_b16 v[36:37], v15 offset:49152
    ds_read_b64_tr_b16 v[38:39], v15 offset:49664
    v_and_b32 v109, 0xffff0000, v118
    v_lshlrev_b32 v110, 16, v119
    v_and_b32 v111, 0xffff0000, v119
    buffer_load_dwordx4 v[228:231], v2, s[28:31], s78 offen offset:2048 sc1
    v_mfma_f32_32x32x16_bf16 v[64:79], v[40:43], v[164:167], v[64:79]
    ds_read_b64_tr_b16 v[40:41], v13 offset:4096
    ds_read_b64_tr_b16 v[42:43], v13 offset:4608
    v_add_f32 v96, v96, v120
    v_add_f32 v97, v97, v120
    v_add_f32 v98, v98, v120
    v_add_f32 v99, v99, v120
    v_mfma_f32_32x32x16_bf16 v[80:95], v[44:47], v[164:167], v[80:95]
    ds_read_b64_tr_b16 v[44:45], v20 offset:4096
    ds_read_b64_tr_b16 v[46:47], v20 offset:4608
    v_add_f32 v100, v100, v120
    v_add_f32 v101, v101, v120
    s_add_u32 s78, s44, 0x9000
    buffer_load_dwordx4 v[232:235], v2, s[28:31], s78 offen offset:0 sc1
    v_mfma_f32_32x32x16_bf16 v[64:79], v[48:51], v[168:171], v[64:79]
    ds_read_b64_tr_b16 v[48:49], v13 offset:24576
    ds_read_b64_tr_b16 v[50:51], v13 offset:25088
    v_add_f32 v102, v102, v120
    v_add_f32 v103, v103, v120
    v_add_f32 v104, v104, v120
    v_add_f32 v105, v105, v120
    v_mfma_f32_32x32x16_bf16 v[80:95], v[52:55], v[168:171], v[80:95]
    ds_read_b64_tr_b16 v[52:53], v20 offset:24576
    ds_read_b64_tr_b16 v[54:55], v20 offset:25088
    s_waitcnt vmcnt(12)
    v_max3_u32 v29, v176, v180, v184
    v_add_f32 v106, v106, v120
    v_add_f32 v107, v107, v120
    buffer_load_dwordx4 v[236:239], v2, s[28:31], s78 offen offset:2048 sc1
    v_mfma_f32_32x32x16_bf16 v[64:79], v[56:59], v[172:175], v[64:79]
    ds_read_b64_tr_b16 v[56:57], v10 offset:8192
    ds_read_b64_tr_b16 v[58:59], v10 offset:8704
    v_add_f32 v108, v108, v120
    v_add_f32 v109, v109, v120
    v_add_f32 v110, v110, v120
    v_add_f32 v111, v111, v120
    v_mfma_f32_32x32x16_bf16 v[80:95], v[60:63], v[172:175], v[80:95]
    ds_read_b64_tr_b16 v[60:61], v14 offset:8192
    ds_read_b64_tr_b16 v[62:63], v14 offset:8704
    ds_read_b128 v[24:27], v6
    s_waitcnt vmcnt(12)
    v_max_u32 v29, v29, v188
    v_cmp_eq_u32 vcc, -1, v29
    s_nop 0
    s_cbranch_vccnz L_o27
L_b27:
    s_add_u32 s78, s45, 0x8000
    buffer_load_dwordx4 v[240:243], v2, s[28:31], s78 offen offset:0 sc1
    s_waitcnt lgkmcnt(13)
    v_mfma_f32_32x32x16_bf16 v[64:79], v[32:35], v[176:179], v[64:79]
    ds_read_b64_tr_b16 v[32:33], v10 offset:28672
    ds_read_b64_tr_b16 v[34:35], v10 offset:29184
    s_waitcnt lgkmcnt(11)
    v_mfma_f32_32x32x16_bf16 v[80:95], v[36:39], v[176:179], v[80:95]
    ds_read_b64_tr_b16 v[36:37], v14 offset:28672
    ds_read_b64_tr_b16 v[38:39], v14 offset:29184
    buffer_load_dwordx4 v[244:247], v2, s[28:31], s78 offen offset:2048 sc1
    v_mfma_f32_32x32x16_bf16 v[64:79], v[40:43], v[180:183], v[64:79]
    ds_read_b64_tr_b16 v[40:41], v10 offset:49152
    ds_read_b64_tr_b16 v[42:43], v10 offset:49664
    s_waitcnt lgkmcnt(11)
    s_waitcnt lgkmcnt(6)
    v_min3_u32 v24, v24, v25, v26
    v_min_u32 v24, v24, v27
    v_mfma_f32_32x32x16_bf16 v[80:95], v[44:47], v[180:183], v[80:95]
    ds_read_b64_tr_b16 v[44:45], v14 offset:49152
    ds_read_b64_tr_b16 v[46:47], v14 offset:49664
    v_cmp_gt_u32 vcc, 18, v24
    s_nop 0
    s_cbranch_vccnz L_o28
L_b28:
    s_add_u32 s78, s45, 0x9000
    buffer_load_dwordx4 v[248:251], v2, s[28:31], s78 offen offset:0 sc1
    v_mfma_f32_32x32x16_bf16 v[64:79], v[48:51], v[184:187], v[64:79]
    ds_read_b64_tr_b16 v[48:49], v12 offset:4096
    ds_read_b64_tr_b16 v[50:51], v12 offset:4608
    s_waitcnt vmcnt(12)
    v_max3_u32 v29, v192, v196, v200
    v_mfma_f32_32x32x16_bf16 v[80:95], v[52:55], v[184:187], v[80:95]
    ds_read_b64_tr_b16 v[52:53], v15 offset:4096
    ds_read_b64_tr_b16 v[54:55], v15 offset:4608
    buffer_load_dwordx4 v[252:255], v2, s[28:31], s78 offen offset:2048 sc1
    v_mfma_f32_32x32x16_bf16 v[64:79], v[56:59], v[188:191], v[64:79]
    ds_read_b64_tr_b16 v[56:57], v12 offset:24576
    ds_read_b64_tr_b16 v[58:59], v12 offset:25088
    s_waitcnt vmcnt(12)
    v_max_u32 v29, v29, v204
    v_mfma_f32_32x32x16_bf16 v[80:95], v[60:63], v[188:191], v[80:95]
    ds_read_b64_tr_b16 v[60:61], v15 offset:24576
    ds_read_b64_tr_b16 v[62:63], v15 offset:25088
    v_cmp_eq_u32 vcc, -1, v29
    s_nop 0
    s_cbranch_vccnz L_o29
L_b29:
    s_bfe_u64 s[86:87], s[38:39], 0x40000
    s_lshl_b32 s78, s86, 11
    s_add_u32 s78, s78, s72
    s_add_u32 s78, s78, 0x10000
    buffer_load_dwordx4 v[128:131], v2, s[28:31], s78 offen offset:0 sc1
    s_waitcnt lgkmcnt(12)
    v_mfma_f32_32x32x16_bf16 v[64:79], v[32:35], v[192:195], v[64:79]
    ds_read_b64_tr_b16 v[32:33], v12 offset:45056
    ds_read_b64_tr_b16 v[34:35], v12 offset:45568
    s_waitcnt lgkmcnt(10)
    v_mfma_f32_32x32x16_bf16 v[80:95], v[36:39], v[192:195], v[80:95]
    ds_read_b64_tr_b16 v[36:37], v15 offset:45056
    ds_read_b64_tr_b16 v[38:39], v15 offset:45568
    s_bfe_u64 s[86:87], s[38:39], 0x40004
    s_lshl_b32 s78, s86, 11
    s_add_u32 s78, s78, s72
    s_add_u32 s78, s78, 0x10000
    buffer_load_dwordx4 v[132:135], v2, s[28:31], s78 offen offset:0 sc1
    v_mfma_f32_32x32x16_bf16 v[64:79], v[40:43], v[196:199], v[64:79]
    ds_read_b64_tr_b16 v[40:41], v13 offset:0
    ds_read_b64_tr_b16 v[42:43], v13 offset:512
    s_waitcnt vmcnt(11)
    v_max3_u32 v29, v208, v212, v216
    s_waitcnt lgkmcnt(10)
    v_mfma_f32_32x32x16_bf16 v[80:95], v[44:47], v[196:199], v[80:95]
    ds_read_b64_tr_b16 v[44:45], v20 offset:0
    ds_read_b64_tr_b16 v[46:47], v20 offset:512
    s_bfe_u64 s[86:87], s[38:39], 0x40008
    s_lshl_b32 s78, s86, 11
    s_add_u32 s78, s78, s72
    s_add_u32 s78, s78, 0x10000
    buffer_load_dwordx4 v[136:139], v2, s[28:31], s78 offen offset:0 sc1
    v_mfma_f32_32x32x16_bf16 v[64:79], v[48:51], v[200:203], v[64:79]
    ds_read_b64_tr_b16 v[48:49], v13 offset:20480
    ds_read_b64_tr_b16 v[50:51], v13 offset:20992
    s_waitcnt lgkmcnt(10)
    v_mfma_f32_32x32x16_bf16 v[80:95], v[52:55], v[200:203], v[80:95]
    ds_read_b64_tr_b16 v[52:53], v20 offset:20480
    ds_read_b64_tr_b16 v[54:55], v20 offset:20992
    s_bfe_u64 s[86:87], s[38:39], 0x4000c
    s_lshl_b32 s78, s86, 11
    s_add_u32 s78, s78, s72
    s_add_u32 s78, s78, 0x10000
    buffer_load_dwordx4 v[140:143], v2, s[28:31], s78 offen offset:0 sc1
    v_mfma_f32_32x32x16_bf16 v[64:79], v[56:59], v[204:207], v[64:79]
    ds_read_b64_tr_b16 v[56:57], v10 offset:16384
    ds_read_b64_tr_b16 v[58:59], v10 offset:16896
    s_waitcnt vmcnt(12)
    v_max_u32 v29, v29, v220
    v_cmp_eq_u32 vcc, -1, v29
    s_nop 0
    s_cbranch_vccnz L_o30
L_b30:
    v_mfma_f32_32x32x16_bf16 v[80:95], v[60:63], v[204:207], v[80:95]
    ds_read_b64_tr_b16 v[60:61], v14 offset:16384
    ds_read_b64_tr_b16 v[62:63], v14 offset:16896
    ds_read_b128 v[24:27], v6
    s_bfe_u64 s[86:87], s[38:39], 0x40010
    s_lshl_b32 s78, s86, 11
    s_add_u32 s78, s78, s72
    s_add_u32 s78, s78, 0x10000
    buffer_load_dwordx4 v[144:147], v2, s[28:31], s78 offen offset:0 sc1
    s_waitcnt lgkmcnt(13)
    v_mfma_f32_32x32x16_bf16 v[64:79], v[32:35], v[208:211], v[64:79]
    ds_read_b64_tr_b16 v[32:33], v10 offset:36864
    ds_read_b64_tr_b16 v[34:35], v10 offset:37376
    s_waitcnt lgkmcnt(11)
    v_mfma_f32_32x32x16_bf16 v[80:95], v[36:39], v[208:211], v[80:95]
    ds_read_b64_tr_b16 v[36:37], v14 offset:36864
    ds_read_b64_tr_b16 v[38:39], v14 offset:37376
    s_bfe_u64 s[86:87], s[38:39], 0x40014
    s_lshl_b32 s78, s86, 11
    s_add_u32 s78, s78, s72
    s_add_u32 s78, s78, 0x10000
    buffer_load_dwordx4 v[148:151], v2, s[28:31], s78 offen offset:0 sc1
    v_mfma_f32_32x32x16_bf16 v[64:79], v[40:43], v[212:215], v[64:79]
    ds_read_b64_tr_b16 v[40:41], v10 offset:57344
    ds_read_b64_tr_b16 v[42:43], v10 offset:57856
    s_waitcnt lgkmcnt(11)
    v_mfma_f32_32x32x16_bf16 v[80:95], v[44:47], v[212:215], v[80:95]
    ds_read_b64_tr_b16 v[44:45], v14 offset:57344
    ds_read_b64_tr_b16 v[46:47], v14 offset:57856
    s_waitcnt lgkmcnt(8)
    v_min3_u32 v24, v24, v25, v26
    v_min_u32 v24, v24, v27
    v_cmp_gt_u32 vcc, 20, v24
    s_nop 0
    s_cbranch_vccnz L_o31
L_b31:
    s_bfe_u64 s[86:87], s[38:39], 0x40018
    s_lshl_b32 s78, s86, 11
    s_add_u32 s78, s78, s72
    s_add_u32 s78, s78, 0x10000
    buffer_load_dwordx4 v[152:155], v2, s[28:31], s78 offen offset:0 sc1
    v_mfma_f32_32x32x16_bf16 v[64:79], v[48:51], v[216:219], v[64:79]
    ds_read_b64_tr_b16 v[48:49], v12 offset:12288
    ds_read_b64_tr_b16 v[50:51], v12 offset:12800
    s_waitcnt vmcnt(12)
    v_max3_u32 v29, v224, v228, v232
    v_lshl_add_u32 v24, v9, 4, v21
    v_lshrrev_b32 v21, 3, v1
    v_and_b32 v9, 7, v1
    v_mfma_f32_32x32x16_bf16 v[80:95], v[52:55], v[216:219], v[80:95]
    ds_read_b64_tr_b16 v[52:53], v15 offset:12288
    ds_read_b64_tr_b16 v[54:55], v15 offset:12800
    s_lshl_b32 s62, s74, 11
    s_add_u32 s62, s62, s7
    v_lshl_add_u32 v26, v21, 7, s62
    s_bfe_u64 s[86:87], s[38:39], 0x4001c
    s_lshl_b32 s78, s86, 11
    s_add_u32 s78, s78, s72
    s_add_u32 s78, s78, 0x10000
    buffer_load_dwordx4 v[156:159], v2, s[28:31], s78 offen offset:0 sc1
    v_mfma_f32_32x32x16_bf16 v[64:79], v[56:59], v[220:223], v[64:79]
    ds_read_b64_tr_b16 v[56:57], v12 offset:32768
    ds_read_b64_tr_b16 v[58:59], v12 offset:33280
    s_waitcnt vmcnt(12)
    v_max_u32 v29, v29, v236
    v_cmp_eq_u32 vcc, -1, v29
    s_nop 0
    s_cbranch_vccnz L_o32
L_b32:
    v_mfma_f32_32x32x16_bf16 v[80:95], v[60:63], v[220:223], v[80:95]
    ds_read_b64_tr_b16 v[60:61], v15 offset:32768
    ds_read_b64_tr_b16 v[62:63], v15 offset:33280
    s_waitcnt lgkmcnt(12)
    s_bfe_u64 s[86:87], s[38:39], 0x40020
    s_lshl_b32 s78, s86, 11
    s_add_u32 s78, s78, s72
    s_add_u32 s78, s78, 0x10000
    buffer_load_dwordx4 v[160:163], v2, s[28:31], s78 offen offset:0 sc1
    v_mfma_f32_32x32x16_bf16 v[64:79], v[32:35], v[224:227], v[64:79]
    ds_read_b64_tr_b16 v[32:33], v12 offset:53248
    ds_read_b64_tr_b16 v[34:35], v12 offset:53760
    s_waitcnt lgkmcnt(10)
    v_lshlrev_b32 v27, 16, v21
    v_lshl_add_u32 v27, v9, 4, v27
    v_xor_b32 v9, v9, v21
    v_xor_b32 v25, 16, v24
    v_mfma_f32_32x32x16_bf16 v[80:95], v[36:39], v[224:227], v[80:95]
    ds_read_b64_tr_b16 v[36:37], v15 offset:53248
    ds_read_b64_tr_b16 v[38:39], v15 offset:53760
    v_lshl_add_u32 v26, v9, 4, v26
    v_mfma_f32_32x32x16_bf16 v[64:79], v[40:43], v[228:231], v[64:79]
    s_bfe_u64 s[86:87], s[38:39], 0x40024
    s_lshl_b32 s78, s86, 11
    s_add_u32 s78, s78, s72
    s_add_u32 s78, s78, 0x10000
    buffer_load_dwordx4 v[164:167], v2, s[28:31], s78 offen offset:0 sc1
    ds_read_b64_tr_b16 v[40:41], v13 offset:8192
    s_waitcnt lgkmcnt(9)
    v_mfma_f32_32x32x16_bf16 v[80:95], v[44:47], v[228:231], v[80:95]
    ds_read_b64_tr_b16 v[42:43], v13 offset:8704
    ds_read_b64_tr_b16 v[44:45], v20 offset:8192
    ds_read_b64_tr_b16 v[46:47], v20 offset:8704
    v_mfma_f32_32x32x16_bf16 v[64:79], v[48:51], v[232:235], v[64:79]
    ds_read_b64_tr_b16 v[48:49], v10 offset:0
    ds_read_b64_tr_b16 v[50:51], v10 offset:512
    s_bfe_u64 s[86:87], s[38:39], 0x40028
    s_lshl_b32 s78, s86, 11
    s_add_u32 s78, s78, s72
    s_add_u32 s78, s78, 0x10000
    buffer_load_dwordx4 v[168:171], v2, s[28:31], s78 offen offset:0 sc1
    v_mfma_f32_32x32x16_bf16 v[80:95], v[52:55], v[232:235], v[80:95]
    ds_read_b64_tr_b16 v[52:53], v14 offset:0
    ds_read_b64_tr_b16 v[54:55], v14 offset:512
    s_waitcnt lgkmcnt(12)
    s_waitcnt vmcnt(12)
    v_max3_u32 v29, v240, v244, v248
    v_mfma_f32_32x32x16_bf16 v[64:79], v[56:59], v[236:239], v[64:79]
    ds_read_b64_tr_b16 v[56:57], v10 offset:4096
    ds_read_b64_tr_b16 v[58:59], v10 offset:4608
    s_waitcnt vmcnt(11)
    v_max_u32 v29, v29, v252
    v_cmp_eq_u32 vcc, -1, v29
    s_nop 0
    s_cbranch_vccnz L_o33
L_b33:
    v_mfma_f32_32x32x16_bf16 v[80:95], v[60:63], v[236:239], v[80:95]
    ds_read_b64_tr_b16 v[60:61], v14 offset:4096
    ds_read_b64_tr_b16 v[62:63], v14 offset:4608
    s_waitcnt lgkmcnt(12)
    v_mfma_f32_32x32x16_bf16 v[64:79], v[32:35], v[240:243], v[64:79]
    ds_read_b64_tr_b16 v[32:33], v10 offset:20480
    ds_read_b64_tr_b16 v[34:35], v10 offset:20992
    v_mfma_f32_32x32x16_bf16 v[80:95], v[36:39], v[240:243], v[80:95]
    ds_read_b64_tr_b16 v[36:37], v14 offset:20480
    ds_read_b64_tr_b16 v[38:39], v14 offset:20992
    s_waitcnt lgkmcnt(12)
    v_mfma_f32_32x32x16_bf16 v[64:79], v[40:43], v[244:247], v[64:79]
    ds_read_b64_tr_b16 v[40:41], v10 offset:24576
    ds_read_b64_tr_b16 v[42:43], v10 offset:25088
    v_mfma_f32_32x32x16_bf16 v[80:95], v[44:47], v[244:247], v[80:95]
    ds_read_b64_tr_b16 v[44:45], v14 offset:24576
    ds_read_b64_tr_b16 v[46:47], v14 offset:25088
    s_waitcnt lgkmcnt(12)
    v_mfma_f32_32x32x16_bf16 v[64:79], v[48:51], v[248:251], v[64:79]
    ds_read_b64_tr_b16 v[48:49], v10 offset:40960
    ds_read_b64_tr_b16 v[50:51], v10 offset:41472
    s_waitcnt vmcnt(8)
    v_max3_u32 v29, v128, v132, v136
    v_mfma_f32_32x32x16_bf16 v[80:95], v[52:55], v[248:251], v[80:95]
    ds_read_b64_tr_b16 v[52:53], v14 offset:40960
    ds_read_b64_tr_b16 v[54:55], v14 offset:41472
    s_waitcnt lgkmcnt(12)
    v_mfma_f32_32x32x16_bf16 v[64:79], v[56:59], v[252:255], v[64:79]
    ds_read_b64_tr_b16 v[56:57], v10 offset:45056
    ds_read_b64_tr_b16 v[58:59], v10 offset:45568
    v_mfma_f32_32x32x16_bf16 v[80:95], v[60:63], v[252:255], v[80:95]
    ds_read_b64_tr_b16 v[60:61], v14 offset:45056
    ds_read_b64_tr_b16 v[62:63], v14 offset:45568
    s_waitcnt vmcnt(7)
    v_max_u32 v29, v29, v140
    v_cmp_eq_u32 vcc, -1, v29
    s_nop 0
    s_cbranch_vccnz L_o34
L_b34:
    s_waitcnt lgkmcnt(12)
    v_mfma_f32_32x32x16_bf16 v[64:79], v[32:35], v[128:131], v[64:79]
    ds_read_b64_tr_b16 v[32:33], v10 offset:61440
    ds_read_b64_tr_b16 v[34:35], v10 offset:61952
    s_barrier
    v_mfma_f32_32x32x16_bf16 v[80:95], v[36:39], v[128:131], v[80:95]
    ds_read_b64_tr_b16 v[36:37], v14 offset:61440
    ds_read_b64_tr_b16 v[38:39], v14 offset:61952
    s_waitcnt lgkmcnt(12)
    v_mfma_f32_32x32x16_bf16 v[64:79], v[40:43], v[132:135], v[64:79]
    ds_read_b64_tr_b16 v[40:41], v12 offset:0
    ds_read_b64_tr_b16 v[42:43], v12 offset:512
    v_mfma_f32_32x32x16_bf16 v[80:95], v[44:47], v[132:135], v[80:95]
    ds_read_b64_tr_b16 v[44:45], v15 offset:0
    ds_read_b64_tr_b16 v[46:47], v15 offset:512
    s_waitcnt lgkmcnt(12)
    v_mfma_f32_32x32x16_bf16 v[64:79], v[48:51], v[136:139], v[64:79]
    ds_read_b64_tr_b16 v[48:49], v12 offset:16384
    ds_read_b64_tr_b16 v[50:51], v12 offset:16896
    v_mfma_f32_32x32x16_bf16 v[80:95], v[52:55], v[136:139], v[80:95]
    ds_read_b64_tr_b16 v[52:53], v15 offset:16384
    ds_read_b64_tr_b16 v[54:55], v15 offset:16896
    s_waitcnt lgkmcnt(12)
    v_mfma_f32_32x32x16_bf16 v[64:79], v[56:59], v[140:143], v[64:79]
    ds_read_b64_tr_b16 v[56:57], v12 offset:20480
    ds_read_b64_tr_b16 v[58:59], v12 offset:20992
    s_waitcnt vmcnt(4)
    v_max3_u32 v29, v144, v148, v152
    v_mfma_f32_32x32x16_bf16 v[80:95], v[60:63], v[140:143], v[80:95]
    ds_read_b64_tr_b16 v[60:61], v15 offset:20480
    ds_read_b64_tr_b16 v[62:63], v15 offset:20992
    s_waitcnt vmcnt(3)
    v_max_u32 v29, v29, v156
    v_cmp_eq_u32 vcc, -1, v29
    s_nop 0
    s_cbranch_vccnz L_o35
L_b35:
    s_waitcnt lgkmcnt(12)
    v_mfma_f32_32x32x16_bf16 v[64:79], v[32:35], v[144:147], v[64:79]
    ds_read_b64_tr_b16 v[32:33], v12 offset:36864
    ds_read_b64_tr_b16 v[34:35], v12 offset:37376
    s_waitcnt lgkmcnt(10)
    v_mfma_f32_32x32x16_bf16 v[80:95], v[36:39], v[144:147], v[80:95]
    ds_read_b64_tr_b16 v[36:37], v15 offset:36864
    ds_read_b64_tr_b16 v[38:39], v15 offset:37376
    v_mfma_f32_32x32x16_bf16 v[64:79], v[40:43], v[148:151], v[64:79]
    ds_read_b64_tr_b16 v[40:41], v12 offset:40960
    ds_read_b64_tr_b16 v[42:43], v12 offset:41472
    s_waitcnt lgkmcnt(10)
    v_mfma_f32_32x32x16_bf16 v[80:95], v[44:47], v[148:151], v[80:95]
    ds_read_b64_tr_b16 v[44:45], v15 offset:40960
    ds_read_b64_tr_b16 v[46:47], v15 offset:41472
    v_mfma_f32_32x32x16_bf16 v[64:79], v[48:51], v[152:155], v[64:79]
    ds_read_b64_tr_b16 v[48:49], v12 offset:57344
    ds_read_b64_tr_b16 v[50:51], v12 offset:57856
    s_waitcnt lgkmcnt(10)
    v_mfma_f32_32x32x16_bf16 v[80:95], v[52:55], v[152:155], v[80:95]
    ds_read_b64_tr_b16 v[52:53], v15 offset:57344
    ds_read_b64_tr_b16 v[54:55], v15 offset:57856
    v_mfma_f32_32x32x16_bf16 v[64:79], v[56:59], v[156:159], v[64:79]
    s_waitcnt vmcnt(0)
    v_max3_u32 v29, v160, v164, v168
    v_cmp_eq_u32 vcc, -1, v29
    s_nop 0
    s_cbranch_vccnz L_o36
L_b36:
    s_waitcnt lgkmcnt(8)
    v_mfma_f32_32x32x16_bf16 v[64:79], v[32:35], v[160:163], v[64:79]
    s_waitcnt lgkmcnt(4)
    v_mfma_f32_32x32x16_bf16 v[64:79], v[40:43], v[164:167], v[64:79]
    s_waitcnt lgkmcnt(0)
    v_mfma_f32_32x32x16_bf16 v[64:79], v[48:51], v[168:171], v[64:79]
    v_mfma_f32_32x32x16_bf16 v[80:95], v[60:63], v[156:159], v[80:95]
    v_mfma_f32_32x32x16_bf16 v[80:95], v[36:39], v[160:163], v[80:95]
    s_nop 9
    ds_write_b128 v22, v[64:67] offset:0
    v_mfma_f32_32x32x16_bf16 v[80:95], v[44:47], v[164:167], v[80:95]
    ds_write_b128 v22, v[68:71] offset:1024
    v_mfma_f32_32x32x16_bf16 v[80:95], v[52:55], v[168:171], v[80:95]
    ds_write_b128 v22, v[72:75] offset:2048
    ds_write_b128 v22, v[76:79] offset:3072
    s_nop 9
    v_pk_add_f32 v[96:97], v[96:97], v[80:81]
    v_pk_add_f32 v[98:99], v[98:99], v[82:83]
    v_pk_add_f32 v[100:101], v[100:101], v[84:85]
    v_pk_add_f32 v[102:103], v[102:103], v[86:87]
    v_pk_add_f32 v[104:105], v[104:105], v[88:89]
    v_pk_add_f32 v[106:107], v[106:107], v[90:91]
    v_pk_add_f32 v[108:109], v[108:109], v[92:93]
    v_pk_add_f32 v[110:111], v[110:111], v[94:95]
    s_waitcnt lgkmcnt(0)
    s_barrier
    ds_read_b128 v[32:35], v23 offset:0
    ds_read_b128 v[36:39], v23 offset:1024
    ds_read_b128 v[40:43], v23 offset:2048
    ds_read_b128 v[44:47], v23 offset:3072
    s_waitcnt lgkmcnt(3)
    v_pk_add_f32 v[32:33], v[32:33], v[96:97]
    v_pk_add_f32 v[34:35], v[34:35], v[98:99]
    s_waitcnt lgkmcnt(2)
    v_pk_add_f32 v[36:37], v[36:37], v[100:101]
    v_pk_add_f32 v[38:39], v[38:39], v[102:103]
    v_cvt_pk_bf16_f32 v56, v32, v33
    v_cvt_pk_bf16_f32 v57, v34, v35
    v_cvt_pk_bf16_f32 v58, v36, v37
    v_cvt_pk_bf16_f32 v59, v38, v39
    ds_write_b128 v24, v[56:59]
    s_waitcnt lgkmcnt(2)
    v_pk_add_f32 v[40:41], v[40:41], v[104:105]
    v_pk_add_f32 v[42:43], v[42:43], v[106:107]
    s_waitcnt lgkmcnt(1)
    v_pk_add_f32 v[44:45], v[44:45], v[108:109]
    v_pk_add_f32 v[46:47], v[46:47], v[110:111]
    v_cvt_pk_bf16_f32 v60, v40, v41
    v_cvt_pk_bf16_f32 v61, v42, v43
    v_cvt_pk_bf16_f32 v62, v44, v45
    v_cvt_pk_bf16_f32 v63, v46, v47
    ds_write_b128 v25, v[60:63]
    s_waitcnt lgkmcnt(0)
    s_barrier
    ds_read_b128 v[32:35], v26
    ds_read_b128 v[36:39], v26 offset:1024
    s_waitcnt lgkmcnt(1)
    buffer_store_dwordx4 v[32:35], v27, s[24:27], s68 offen sc1
    s_waitcnt lgkmcnt(0)
    buffer_store_dwordx4 v[36:39], v27, s[24:27], s69 offen sc1
L_exit:
    s_endpgm
L_o5:
    s_mov_b32 s63, 0
L_s2:
    s_sleep 2
    buffer_load_dword v11, v63, s[28:31], s32 offen sc1
    s_waitcnt vmcnt(0)
    v_cmp_ne_u32 vcc, s33, v11
    s_add_u32 s63, s63, 1
    s_cmp_gt_u32 s63, 100000
    s_cbranch_scc1 L_x2
    s_cbranch_vccnz L_s2
L_x2:
    s_branch L_b5
L_o6:
    s_mov_b32 s63, 0
L_s4:
    s_sleep 2
    s_cmp_lg_u32 s56, 0
    s_cselect_b32 exec_lo, -1, -2
    s_mov_b32 exec_hi, exec_lo
    buffer_load_dword v64, v22, s[28:31], s68 offen offset:0 sc1
    buffer_load_dword v65, v22, s[28:31], s68 offen offset:1024 sc1
    buffer_load_dword v66, v22, s[28:31], s68 offen offset:2048 sc1
    buffer_load_dword v67, v22, s[28:31], s68 offen offset:3072 sc1
    s_add_u32 s83, s68, 0x2000
    buffer_load_dword v68, v22, s[28:31], s83 offen offset:0 sc1
    buffer_load_dword v69, v22, s[28:31], s83 offen offset:1024 sc1
    buffer_load_dword v70, v22, s[28:31], s83 offen offset:2048 sc1
    buffer_load_dword v71, v22, s[28:31], s83 offen offset:3072 sc1
    s_add_u32 s83, s68, 0x4000
    buffer_load_dword v72, v22, s[28:31], s83 offen offset:0 sc1
    buffer_load_dword v73, v22, s[28:31], s83 offen offset:1024 sc1
    buffer_load_dword v74, v22, s[28:31], s83 offen offset:2048 sc1
    buffer_load_dword v75, v22, s[28:31], s83 offen offset:3072 sc1
    s_add_u32 s83, s68, 0x6000
    buffer_load_dword v76, v22, s[28:31], s83 offen offset:0 sc1
    buffer_load_dword v77, v22, s[28:31], s83 offen offset:1024 sc1
    buffer_load_dword v78, v22, s[28:31], s83 offen offset:2048 sc1
    buffer_load_dword v79, v22, s[28:31], s83 offen offset:3072 sc1
    s_cmp_lg_u32 s56, 0
    s_cbranch_scc1 L_nzb
    s_mov_b32 exec_lo, 1
    s_mov_b32 exec_hi, 1
    s_add_u32 s83, s69, 0x1000
    buffer_load_dword v64, v23, s[28:31], s69 offen offset:0 sc1
    buffer_load_dword v65, v23, s[28:31], s69 offen offset:256 sc1
    buffer_load_dword v66, v23, s[28:31], s69 offen offset:512 sc1
    buffer_load_dword v67, v23, s[28:31], s69 offen offset:768 sc1
    buffer_load_dword v68, v23, s[28:31], s69 offen offset:2048 sc1
    buffer_load_dword v69, v23, s[28:31], s69 offen offset:2304 sc1
    buffer_load_dword v70, v23, s[28:31], s69 offen offset:2560 sc1
    buffer_load_dword v71, v23, s[28:31], s69 offen offset:2816 sc1
    buffer_load_dword v72, v23, s[28:31], s83 offen offset:0 sc1
    buffer_load_dword v73, v23, s[28:31], s83 offen offset:256 sc1
    buffer_load_dword v74, v23, s[28:31], s83 offen offset:512 sc1
    buffer_load_dword v75, v23, s[28:31], s83 offen offset:768 sc1
    buffer_load_dword v76, v23, s[28:31], s83 offen offset:2048 sc1
    buffer_load_dword v77, v23, s[28:31], s83 offen offset:2304 sc1
    buffer_load_dword v78, v23, s[28:31], s83 offen offset:2560 sc1
    buffer_load_dword v79, v23, s[28:31], s83 offen offset:2816 sc1
    s_mov_b64 exec, -1
L_nzb:
    s_waitcnt vmcnt(0)
    v_max3_u32 v29, v64, v65, v66
    v_max3_u32 v29, v29, v67, v68
    v_max3_u32 v29, v29, v69, v70
    v_max3_u32 v29, v29, v71, v72
    v_max3_u32 v29, v29, v73, v74
    v_max3_u32 v29, v29, v75, v76
    v_max3_u32 v29, v29, v77, v78
    v_max_u32 v29, v29, v79
    v_cmp_eq_u32 vcc, -1, v29
    s_add_u32 s63, s63, 1
    s_cmp_gt_u32 s63, 100000
    s_cbranch_scc1 L_x4
    s_cbranch_vccnz L_s4
L_x4:
    s_branch L_b6
L_o7:
    s_mov_b32 s63, 0
L_s5:
    ds_read_b32 v31, v6 offset:44
    s_waitcnt lgkmcnt(0)
    v_cmp_gt_u32 vcc, 4, v31
    s_add_u32 s63, s63, 1
    s_cmp_gt_u32 s63, 100000
    s_cbranch_scc1 L_x5
    s_cbranch_vccnz L_s5
L_x5:
    s_branch L_b7
L_o8:
    s_mov_b32 s63, 0
L_s6:
    s_sleep 2
    buffer_load_dword v30, v18, s[28:31], s32 offen sc1
    s_waitcnt vmcnt(0)
    v_cmp_ne_u32 vcc, s33, v30
    s_add_u32 s63, s63, 1
    s_cmp_gt_u32 s63, 100000
    s_cbranch_scc1 L_x6
    s_cbranch_vccnz L_s6
L_x6:
    s_branch L_b8
L_o9:
    s_mov_b32 s63, 0
L_s7:
    ds_read_b128 v[24:27], v6
    s_waitcnt lgkmcnt(0)
    v_min3_u32 v24, v24, v25, v26
    v_min_u32 v24, v24, v27
    v_cmp_gt_u32 vcc, 8, v24
    s_add_u32 s63, s63, 1
    s_cmp_gt_u32 s63, 100000
    s_cbranch_scc1 L_x7
    s_cbranch_vccnz L_s7
L_x7:
    s_branch L_b9
L_o10:
    s_mov_b32 s63, 0
L_s8:
    s_sleep 2
    s_add_u32 s83, s41, 0x0
    s_and_b32 s83, s83, 0x7fff
    s_add_u32 s83, s83, s82
    buffer_load_dwordx4 v[128:131], v2, s[28:31], s83 offen offset:0 sc1
    buffer_load_dwordx4 v[132:135], v2, s[28:31], s83 offen offset:1024 sc1
    buffer_load_dwordx4 v[136:139], v2, s[28:31], s83 offen offset:2048 sc1
    buffer_load_dwordx4 v[140:143], v2, s[28:31], s83 offen offset:3072 sc1
    s_waitcnt vmcnt(0)
    v_max3_u32 v29, v128, v132, v136
    v_max_u32 v29, v29, v140
    v_cmp_eq_u32 vcc, -1, v29
    s_add_u32 s63, s63, 1
    s_cmp_gt_u32 s63, 100000
    s_cbranch_scc1 L_x8
    s_cbranch_vccnz L_s8
L_x8:
    s_branch L_b10
L_o11:
    s_mov_b32 s63, 0
L_s9:
    s_sleep 2
    s_add_u32 s83, s41, 0x1000
    s_and_b32 s83, s83, 0x7fff
    s_add_u32 s83, s83, s82
    buffer_load_dwordx4 v[144:147], v2, s[28:31], s83 offen offset:0 sc1
    buffer_load_dwordx4 v[148:151], v2, s[28:31], s83 offen offset:1024 sc1
    buffer_load_dwordx4 v[152:155], v2, s[28:31], s83 offen offset:2048 sc1
    buffer_load_dwordx4 v[156:159], v2, s[28:31], s83 offen offset:3072 sc1
    s_waitcnt vmcnt(0)
    v_max3_u32 v29, v144, v148, v152
    v_max_u32 v29, v29, v156
    v_cmp_eq_u32 vcc, -1, v29
    s_add_u32 s63, s63, 1
    s_cmp_gt_u32 s63, 100000
    s_cbranch_scc1 L_x9
    s_cbranch_vccnz L_s9
L_x9:
    s_branch L_b11
L_o12:
    s_mov_b32 s63, 0
L_s10:
    s_sleep 2
    s_add_u32 s83, s41, 0x2000
    s_and_b32 s83, s83, 0x7fff
    s_add_u32 s83, s83, s82
    buffer_load_dwordx4 v[160:163], v2, s[28:31], s83 offen offset:0 sc1
    buffer_load_dwordx4 v[164:167], v2, s[28:31], s83 offen offset:1024 sc1
    buffer_load_dwordx4 v[168:171], v2, s[28:31], s83 offen offset:2048 sc1
    buffer_load_dwordx4 v[172:175], v2, s[28:31], s83 offen offset:3072 sc1
    s_waitcnt vmcnt(0)
    v_max3_u32 v29, v160, v164, v168
    v_max_u32 v29, v29, v172
    v_cmp_eq_u32 vcc, -1, v29
    s_add_u32 s63, s63, 1
    s_cmp_gt_u32 s63, 100000
    s_cbranch_scc1 L_x10
    s_cbranch_vccnz L_s10
L_x10:
    s_branch L_b12
L_o13:
    s_mov_b32 s63, 0
L_s11:
    s_sleep 2
    s_add_u32 s83, s41, 0x3000
    s_and_b32 s83, s83, 0x7fff
    s_add_u32 s83, s83, s82
    buffer_load_dwordx4 v[176:179], v2, s[28:31], s83 offen offset:0 sc1
    buffer_load_dwordx4 v[180:183], v2, s[28:31], s83 offen offset:1024 sc1
    buffer_load_dwordx4 v[184:187], v2, s[28:31], s83 offen offset:2048 sc1
    buffer_load_dwordx4 v[188:191], v2, s[28:31], s83 offen offset:3072 sc1
    s_waitcnt vmcnt(0)
    v_max3_u32 v29, v176, v180, v184
    v_max_u32 v29, v29, v188
    v_cmp_eq_u32 vcc, -1, v29
    s_add_u32 s63, s63, 1
    s_cmp_gt_u32 s63, 100000
    s_cbranch_scc1 L_x11
    s_cbranch_vccnz L_s11
L_x11:
    s_branch L_b13
L_o14:
    s_mov_b32 s63, 0
L_s12:
    s_sleep 2
    s_add_u32 s83, s41, 0x4000
    s_and_b32 s83, s83, 0x7fff
    s_add_u32 s83, s83, s82
    buffer_load_dwordx4 v[192:195], v2, s[28:31], s83 offen offset:0 sc1
    buffer_load_dwordx4 v[196:199], v2, s[28:31], s83 offen offset:1024 sc1
    buffer_load_dwordx4 v[200:203], v2, s[28:31], s83 offen offset:2048 sc1
    buffer_load_dwordx4 v[204:207], v2, s[28:31], s83 offen offset:3072 sc1
    s_waitcnt vmcnt(0)
    v_max3_u32 v29, v192, v196, v200
    v_max_u32 v29, v29, v204
    v_cmp_eq_u32 vcc, -1, v29
    s_add_u32 s63, s63, 1
    s_cmp_gt_u32 s63, 100000
    s_cbranch_scc1 L_x12
    s_cbranch_vccnz L_s12
L_x12:
    s_branch L_b14
L_o15:
    s_mov_b32 s63, 0
L_s13:
    s_sleep 2
    s_add_u32 s83, s41, 0x5000
    s_and_b32 s83, s83, 0x7fff
    s_add_u32 s83, s83, s82
    buffer_load_dwordx4 v[208:211], v2, s[28:31], s83 offen offset:0 sc1
    buffer_load_dwordx4 v[212:215], v2, s[28:31], s83 offen offset:1024 sc1
    buffer_load_dwordx4 v[216:219], v2, s[28:31], s83 offen offset:2048 sc1
    buffer_load_dwordx4 v[220:223], v2, s[28:31], s83 offen offset:3072 sc1
    s_waitcnt vmcnt(0)
    v_max3_u32 v29, v208, v212, v216
    v_max_u32 v29, v29, v220
    v_cmp_eq_u32 vcc, -1, v29
    s_add_u32 s63, s63, 1
    s_cmp_gt_u32 s63, 100000
    s_cbranch_scc1 L_x13
    s_cbranch_vccnz L_s13
L_x13:
    s_branch L_b15
L_o16:
    s_mov_b32 s63, 0
L_s14:
    s_sleep 2
    s_add_u32 s83, s41, 0x6000
    s_and_b32 s83, s83, 0x7fff
    s_add_u32 s83, s83, s82
    buffer_load_dwordx4 v[224:227], v2, s[28:31], s83 offen offset:0 sc1
    buffer_load_dwordx4 v[228:231], v2, s[28:31], s83 offen offset:1024 sc1
    buffer_load_dwordx4 v[232:235], v2, s[28:31], s83 offen offset:2048 sc1
    buffer_load_dwordx4 v[236:239], v2, s[28:31], s83 offen offset:3072 sc1
    s_waitcnt vmcnt(0)
    v_max3_u32 v29, v224, v228, v232
    v_max_u32 v29, v29, v236
    v_cmp_eq_u32 vcc, -1, v29
    s_add_u32 s63, s63, 1
    s_cmp_gt_u32 s63, 100000
    s_cbranch_scc1 L_x14
    s_cbranch_vccnz L_s14
L_x14:
    s_branch L_b16
L_o18:
    s_mov_b32 s63, 0
L_s16:
    ds_read_b128 v[24:27], v6
    s_waitcnt lgkmcnt(0)
    v_min3_u32 v24, v24, v25, v26
    v_min_u32 v24, v24, v27
    v_cmp_gt_u32 vcc, 9, v24
    s_add_u32 s63, s63, 1
    s_cmp_gt_u32 s63, 100000
    s_cbranch_scc1 L_x16
    s_cbranch_vccnz L_s16
L_x16:
    s_branch L_b18
L_o17:
    s_mov_b32 s63, 0
L_s15:
    s_sleep 2
    s_add_u32 s83, s41, 0x7000
    s_and_b32 s83, s83, 0x7fff
    s_add_u32 s83, s83, s82
    buffer_load_dwordx4 v[240:243], v2, s[28:31], s83 offen offset:0 sc1
    buffer_load_dwordx4 v[244:247], v2, s[28:31], s83 offen offset:1024 sc1
    buffer_load_dwordx4 v[248:251], v2, s[28:31], s83 offen offset:2048 sc1
    buffer_load_dwordx4 v[252:255], v2, s[28:31], s83 offen offset:3072 sc1
    s_waitcnt vmcnt(0)
    v_max3_u32 v29, v240, v244, v248
    v_max_u32 v29, v29, v252
    v_cmp_eq_u32 vcc, -1, v29
    s_add_u32 s63, s63, 1
    s_cmp_gt_u32 s63, 100000
    s_cbranch_scc1 L_x15
    s_cbranch_vccnz L_s15
L_x15:
    s_branch L_b17
L_o19:
    s_mov_b32 s63, 0
L_s17:
    buffer_load_dword v96, v9, s[28:31], s6 offen offset:0 sc1
    buffer_load_dword v97, v9, s[28:31], s6 offen offset:128 sc1
    buffer_load_dword v98, v9, s[28:31], s6 offen offset:256 sc1
    buffer_load_dword v99, v9, s[28:31], s6 offen offset:384 sc1
    buffer_load_dword v100, v9, s[28:31], s6 offen offset:512 sc1
    buffer_load_dword v101, v9, s[28:31], s6 offen offset:640 sc1
    buffer_load_dword v102, v9, s[28:31], s6 offen offset:768 sc1
    buffer_load_dword v103, v9, s[28:31], s6 offen offset:896 sc1
    s_waitcnt vmcnt(0)
    v_max3_u32 v29, v96, v97, v98
    v_max3_u32 v29, v29, v99, v100
    v_max3_u32 v29, v29, v101, v102
    v_max_u32 v29, v29, v103
    v_cmp_eq_u32 vcc, -1, v29
    s_add_u32 s63, s63, 1
    s_cmp_gt_u32 s63, 100000
    s_cbranch_scc1 L_x17
    s_cbranch_vccnz L_s17
L_x17:
    s_branch L_b19
L_o20:
    s_mov_b32 s63, 0
L_s18:
    ds_read_b128 v[24:27], v6
    s_waitcnt lgkmcnt(0)
    v_min3_u32 v24, v24, v25, v26
    v_min_u32 v24, v24, v27
    v_cmp_gt_u32 vcc, 12, v24
    s_add_u32 s63, s63, 1
    s_cmp_gt_u32 s63, 100000
    s_cbranch_scc1 L_x18
    s_cbranch_vccnz L_s18
L_x18:
    s_branch L_b20
L_o21:
    s_mov_b32 s63, 0
L_s19:
    s_sleep 2
    buffer_load_dword v31, v18, s[28:31], s5 offen sc1
    s_waitcnt vmcnt(0)
    v_cmp_ne_u32 vcc, s33, v31
    s_add_u32 s63, s63, 1
    s_cmp_gt_u32 s63, 100000
    s_cbranch_scc1 L_x19
    s_cbranch_vccnz L_s19
L_x19:
    s_branch L_b21
L_o22:
    s_mov_b32 s63, 0
L_s20:
    ds_read_b128 v[24:27], v6
    s_waitcnt lgkmcnt(0)
    v_min3_u32 v24, v24, v25, v26
    v_min_u32 v24, v24, v27
    v_cmp_gt_u32 vcc, 14, v24
    s_add_u32 s63, s63, 1
    s_cmp_gt_u32 s63, 100000
    s_cbranch_scc1 L_x20
    s_cbranch_vccnz L_s20
L_x20:
    s_branch L_b22
L_o23:
    s_mov_b32 s63, 0
L_s21:
    s_sleep 2
    s_add_u32 s83, s42, 0x0
    buffer_load_dwordx4 v[128:131], v2, s[28:31], s83 offen sc1
    s_add_u32 s83, s42, 0x800
    buffer_load_dwordx4 v[132:135], v2, s[28:31], s83 offen sc1
    s_add_u32 s83, s42, 0x1000
    buffer_load_dwordx4 v[136:139], v2, s[28:31], s83 offen sc1
    s_add_u32 s83, s42, 0x1800
    buffer_load_dwordx4 v[140:143], v2, s[28:31], s83 offen sc1
    s_waitcnt vmcnt(0)
    v_max3_u32 v29, v128, v132, v136
    v_max_u32 v29, v29, v140
    v_cmp_eq_u32 vcc, -1, v29
    s_add_u32 s63, s63, 1
    s_cmp_gt_u32 s63, 100000
    s_cbranch_scc1 L_x21
    s_cbranch_vccnz L_s21
L_x21:
    s_branch L_b23
L_o24:
    s_mov_b32 s63, 0
L_s22:
    s_sleep 2
    s_add_u32 s83, s43, 0x0
    buffer_load_dwordx4 v[144:147], v2, s[28:31], s83 offen sc1
    s_add_u32 s83, s43, 0x800
    buffer_load_dwordx4 v[148:151], v2, s[28:31], s83 offen sc1
    s_add_u32 s83, s43, 0x1000
    buffer_load_dwordx4 v[152:155], v2, s[28:31], s83 offen sc1
    s_add_u32 s83, s43, 0x1800
    buffer_load_dwordx4 v[156:159], v2, s[28:31], s83 offen sc1
    s_waitcnt vmcnt(0)
    v_max3_u32 v29, v144, v148, v152
    v_max_u32 v29, v29, v156
    v_cmp_eq_u32 vcc, -1, v29
    s_add_u32 s63, s63, 1
    s_cmp_gt_u32 s63, 100000
    s_cbranch_scc1 L_x22
    s_cbranch_vccnz L_s22
L_x22:
    s_branch L_b24
L_o25:
    s_mov_b32 s63, 0
L_s23:
    ds_read_b128 v[24:27], v6
    s_waitcnt lgkmcnt(0)
    v_min3_u32 v24, v24, v25, v26
    v_min_u32 v24, v24, v27
    v_cmp_gt_u32 vcc, 16, v24
    s_add_u32 s63, s63, 1
    s_cmp_gt_u32 s63, 100000
    s_cbranch_scc1 L_x23
    s_cbranch_vccnz L_s23
L_x23:
    s_branch L_b25
L_o37:
    s_mov_b32 s63, 0
L_s35:
    s_sleep 2
    buffer_load_dwordx4 v[112:115], v11, s[28:31], s82 offen sc1
    buffer_load_dwordx4 v[116:119], v11, s[28:31], s82 offen offset:512 sc1
    buffer_load_dword v120, v7, s[28:31], s6 offen sc1
    s_waitcnt vmcnt(0)
    v_max3_u32 v30, v112, v116, v120
    v_cmp_eq_u32 vcc, -1, v30
    s_add_u32 s63, s63, 1
    s_cmp_gt_u32 s63, 100000
    s_cbranch_scc1 L_x35
    s_cbranch_vccnz L_s35
L_x35:
    s_branch L_b37
L_o26:
    s_mov_b32 s63, 0
L_s24:
    s_sleep 2
    s_add_u32 s83, s44, 0x0
    buffer_load_dwordx4 v[160:163], v2, s[28:31], s83 offen sc1
    s_add_u32 s83, s44, 0x800
    buffer_load_dwordx4 v[164:167], v2, s[28:31], s83 offen sc1
    s_add_u32 s83, s44, 0x1000
    buffer_load_dwordx4 v[168:171], v2, s[28:31], s83 offen sc1
    s_add_u32 s83, s44, 0x1800
    buffer_load_dwordx4 v[172:175], v2, s[28:31], s83 offen sc1
    s_waitcnt vmcnt(0)
    v_max3_u32 v29, v160, v164, v168
    v_max_u32 v29, v29, v172
    v_cmp_eq_u32 vcc, -1, v29
    s_add_u32 s63, s63, 1
    s_cmp_gt_u32 s63, 100000
    s_cbranch_scc1 L_x24
    s_cbranch_vccnz L_s24
L_x24:
    s_branch L_b26
L_o27:
    s_mov_b32 s63, 0
L_s25:
    s_sleep 2
    s_add_u32 s83, s45, 0x0
    buffer_load_dwordx4 v[176:179], v2, s[28:31], s83 offen sc1
    s_add_u32 s83, s45, 0x800
    buffer_load_dwordx4 v[180:183], v2, s[28:31], s83 offen sc1
    s_add_u32 s83, s45, 0x1000
    buffer_load_dwordx4 v[184:187], v2, s[28:31], s83 offen sc1
    s_add_u32 s83, s45, 0x1800
    buffer_load_dwordx4 v[188:191], v2, s[28:31], s83 offen sc1
    s_waitcnt vmcnt(0)
    v_max3_u32 v29, v176, v180, v184
    v_max_u32 v29, v29, v188
    v_cmp_eq_u32 vcc, -1, v29
    s_add_u32 s63, s63, 1
    s_cmp_gt_u32 s63, 100000
    s_cbranch_scc1 L_x25
    s_cbranch_vccnz L_s25
L_x25:
    s_branch L_b27
L_o28:
    s_mov_b32 s63, 0
L_s26:
    ds_read_b128 v[24:27], v6
    s_waitcnt lgkmcnt(0)
    v_min3_u32 v24, v24, v25, v26
    v_min_u32 v24, v24, v27
    v_cmp_gt_u32 vcc, 18, v24
    s_add_u32 s63, s63, 1
    s_cmp_gt_u32 s63, 100000
    s_cbranch_scc1 L_x26
    s_cbranch_vccnz L_s26
L_x26:
    s_branch L_b28
L_o29:
    s_mov_b32 s63, 0
L_s27:
    s_sleep 2
    s_add_u32 s83, s42, 0x8000
    buffer_load_dwordx4 v[192:195], v2, s[28:31], s83 offen sc1
    s_add_u32 s83, s42, 0x8800
    buffer_load_dwordx4 v[196:199], v2, s[28:31], s83 offen sc1
    s_add_u32 s83, s42, 0x9000
    buffer_load_dwordx4 v[200:203], v2, s[28:31], s83 offen sc1
    s_add_u32 s83, s42, 0x9800
    buffer_load_dwordx4 v[204:207], v2, s[28:31], s83 offen sc1
    s_waitcnt vmcnt(0)
    v_max3_u32 v29, v192, v196, v200
    v_max_u32 v29, v29, v204
    v_cmp_eq_u32 vcc, -1, v29
    s_add_u32 s63, s63, 1
    s_cmp_gt_u32 s63, 100000
    s_cbranch_scc1 L_x27
    s_cbranch_vccnz L_s27
L_x27:
    s_branch L_b29
L_o30:
    s_mov_b32 s63, 0
L_s28:
    s_sleep 2
    s_add_u32 s83, s43, 0x8000
    buffer_load_dwordx4 v[208:211], v2, s[28:31], s83 offen sc1
    s_add_u32 s83, s43, 0x8800
    buffer_load_dwordx4 v[212:215], v2, s[28:31], s83 offen sc1
    s_add_u32 s83, s43, 0x9000
    buffer_load_dwordx4 v[216:219], v2, s[28:31], s83 offen sc1
    s_add_u32 s83, s43, 0x9800
    buffer_load_dwordx4 v[220:223], v2, s[28:31], s83 offen sc1
    s_waitcnt vmcnt(0)
    v_max3_u32 v29, v208, v212, v216
    v_max_u32 v29, v29, v220
    v_cmp_eq_u32 vcc, -1, v29
    s_add_u32 s63, s63, 1
    s_cmp_gt_u32 s63, 100000
    s_cbranch_scc1 L_x28
    s_cbranch_vccnz L_s28
L_x28:
    s_branch L_b30
L_o31:
    s_mov_b32 s63, 0
L_s29:
    ds_read_b128 v[24:27], v6
    s_waitcnt lgkmcnt(0)
    v_min3_u32 v24, v24, v25, v26
    v_min_u32 v24, v24, v27
    v_cmp_gt_u32 vcc, 20, v24
    s_add_u32 s63, s63, 1
    s_cmp_gt_u32 s63, 100000
    s_cbranch_scc1 L_x29
    s_cbranch_vccnz L_s29
L_x29:
    s_branch L_b31
L_o32:
    s_mov_b32 s63, 0
L_s30:
    s_sleep 2
    s_add_u32 s83, s44, 0x8000
    buffer_load_dwordx4 v[224:227], v2, s[28:31], s83 offen sc1
    s_add_u32 s83, s44, 0x8800
    buffer_load_dwordx4 v[228:231], v2, s[28:31], s83 offen sc1
    s_add_u32 s83, s44, 0x9000
    buffer_load_dwordx4 v[232:235], v2, s[28:31], s83 offen sc1
    s_add_u32 s83, s44, 0x9800
    buffer_load_dwordx4 v[236:239], v2, s[28:31], s83 offen sc1
    s_waitcnt vmcnt(0)
    v_max3_u32 v29, v224, v228, v232
    v_max_u32 v29, v29, v236
    v_cmp_eq_u32 vcc, -1, v29
    s_add_u32 s63, s63, 1
    s_cmp_gt_u32 s63, 100000
    s_cbranch_scc1 L_x30
    s_cbranch_vccnz L_s30
L_x30:
    s_branch L_b32
L_o33:
    s_mov_b32 s63, 0
L_s31:
    s_sleep 2
    s_add_u32 s83, s45, 0x8000
    buffer_load_dwordx4 v[240:243], v2, s[28:31], s83 offen sc1
    s_add_u32 s83, s45, 0x8800
    buffer_load_dwordx4 v[244:247], v2, s[28:31], s83 offen sc1
    s_add_u32 s83, s45, 0x9000
    buffer_load_dwordx4 v[248:251], v2, s[28:31], s83 offen sc1
    s_add_u32 s83, s45, 0x9800
    buffer_load_dwordx4 v[252:255], v2, s[28:31], s83 offen sc1
    s_waitcnt vmcnt(0)
    v_max3_u32 v29, v240, v244, v248
    v_max_u32 v29, v29, v252
    v_cmp_eq_u32 vcc, -1, v29
    s_add_u32 s63, s63, 1
    s_cmp_gt_u32 s63, 100000
    s_cbranch_scc1 L_x31
    s_cbranch_vccnz L_s31
L_x31:
    s_branch L_b33
L_o34:
    s_mov_b32 s63, 0
L_s32:
    s_sleep 2
    s_bfe_u64 s[86:87], s[38:39], 0x40000
    s_lshl_b32 s83, s86, 11
    s_add_u32 s83, s83, s72
    s_add_u32 s83, s83, 0x10000
    buffer_load_dwordx4 v[128:131], v2, s[28:31], s83 offen sc1
    s_bfe_u64 s[86:87], s[38:39], 0x40004
    s_lshl_b32 s83, s86, 11
    s_add_u32 s83, s83, s72
    s_add_u32 s83, s83, 0x10000
    buffer_load_dwordx4 v[132:135], v2, s[28:31], s83 offen sc1
    s_bfe_u64 s[86:87], s[38:39], 0x40008
    s_lshl_b32 s83, s86, 11
    s_add_u32 s83, s83, s72
    s_add_u32 s83, s83, 0x10000
    buffer_load_dwordx4 v[136:139], v2, s[28:31], s83 offen sc1
    s_bfe_u64 s[86:87], s[38:39], 0x4000c
    s_lshl_b32 s83, s86, 11
    s_add_u32 s83, s83, s72
    s_add_u32 s83, s83, 0x10000
    buffer_load_dwordx4 v[140:143], v2, s[28:31], s83 offen sc1
    s_waitcnt vmcnt(0)
    v_max3_u32 v29, v128, v132, v136
    v_max_u32 v29, v29, v140
    v_cmp_eq_u32 vcc, -1, v29
    s_add_u32 s63, s63, 1
    s_cmp_gt_u32 s63, 100000
    s_cbranch_scc1 L_x32
    s_cbranch_vccnz L_s32
L_x32:
    s_branch L_b34
L_o35:
    s_mov_b32 s63, 0
L_s33:
    s_sleep 2
    s_bfe_u64 s[86:87], s[38:39], 0x40010
    s_lshl_b32 s83, s86, 11
    s_add_u32 s83, s83, s72
    s_add_u32 s83, s83, 0x10000
    buffer_load_dwordx4 v[144:147], v2, s[28:31], s83 offen sc1
    s_bfe_u64 s[86:87], s[38:39], 0x40014
    s_lshl_b32 s83, s86, 11
    s_add_u32 s83, s83, s72
    s_add_u32 s83, s83, 0x10000
    buffer_load_dwordx4 v[148:151], v2, s[28:31], s83 offen sc1
    s_bfe_u64 s[86:87], s[38:39], 0x40018
    s_lshl_b32 s83, s86, 11
    s_add_u32 s83, s83, s72
    s_add_u32 s83, s83, 0x10000
    buffer_load_dwordx4 v[152:155], v2, s[28:31], s83 offen sc1
    s_bfe_u64 s[86:87], s[38:39], 0x4001c
    s_lshl_b32 s83, s86, 11
    s_add_u32 s83, s83, s72
    s_add_u32 s83, s83, 0x10000
    buffer_load_dwordx4 v[156:159], v2, s[28:31], s83 offen sc1
    s_waitcnt vmcnt(0)
    v_max3_u32 v29, v144, v148, v152
    v_max_u32 v29, v29, v156
    v_cmp_eq_u32 vcc, -1, v29
    s_add_u32 s63, s63, 1
    s_cmp_gt_u32 s63, 100000
    s_cbranch_scc1 L_x33
    s_cbranch_vccnz L_s33
L_x33:
    s_branch L_b35
L_o36:
    s_mov_b32 s63, 0
L_s34:
    s_sleep 2
    s_bfe_u64 s[86:87], s[38:39], 0x40020
    s_lshl_b32 s83, s86, 11
    s_add_u32 s83, s83, s72
    s_add_u32 s83, s83, 0x10000
    buffer_load_dwordx4 v[160:163], v2, s[28:31], s83 offen sc1
    s_bfe_u64 s[86:87], s[38:39], 0x40024
    s_lshl_b32 s83, s86, 11
    s_add_u32 s83, s83, s72
    s_add_u32 s83, s83, 0x10000
    buffer_load_dwordx4 v[164:167], v2, s[28:31], s83 offen sc1
    s_bfe_u64 s[86:87], s[38:39], 0x40028
    s_lshl_b32 s83, s86, 11
    s_add_u32 s83, s83, s72
    s_add_u32 s83, s83, 0x10000
    buffer_load_dwordx4 v[168:171], v2, s[28:31], s83 offen sc1
    s_waitcnt vmcnt(0)
    v_max3_u32 v29, v160, v164, v168
    v_cmp_eq_u32 vcc, -1, v29
    s_add_u32 s63, s63, 1
    s_cmp_gt_u32 s63, 100000
    s_cbranch_scc1 L_x34
    s_cbranch_vccnz L_s34
L_x34:
    s_branch L_b36
L_helper:
    s_lshr_b32 s60, s2, 3
    s_lshl_b32 s60, s60, 2
    s_add_u32 s60, s60, s48
    v_mul_u32_u24 v5, 2752, v19
    v_lshl_add_u32 v5, v18, 7, v5
    s_and_b32 s59, s49, 3
    s_mul_i32 s59, s59, 172
    s_add_u32 s59, s59, 8
    s_lshr_b32 s59, s59, 4
    s_lshl_b32 s84, s59, 6
    s_mul_i32 s59, s60, 11008
    s_add_u32 s84, s84, s59
    s_mul_i32 s85, s60, 11264
    v_lshrrev_b32 v23, 2, v1
    v_lshlrev_b32 v7, 10, v23
    v_and_b32 v22, 3, v1
    v_lshl_add_u32 v7, v22, 7, v7
    s_mov_b32 s12, s36
    s_and_b32 s13, s37, 0xffff
    s_mov_b32 s14, 0x158000
    s_mov_b32 s15, 0x20000
    s_mov_b32 s16, s38
    s_and_b32 s17, s39, 0xffff
    s_mov_b32 s18, 0x158000
    s_mov_b32 s19, 0x20000
    s_mov_b32 s20, s40
    s_and_b32 s21, s41, 0xffff
    s_mov_b32 s22, 0x158000
    s_mov_b32 s23, 0x20000
    v_and_b32 v20, 31, v1
    v_lshrrev_b32 v21, 5, v1
    v_lshlrev_b32 v2, 4, v1
    v_mov_b32 v6, 0x27000
    s_and_b32 s53, s49, 3
    s_lshl_b32 s53, s53, 2
    s_lshr_b32 s59, s2, 6
    s_add_u32 s53, s53, s59
    s_bfe_u32 s59, s2, 0x10005
    s_lshl_b32 s59, s59, 5
    s_add_u32 s55, s51, s59
    s_and_b32 s52, s55, 0x33
    s_and_b32 s56, s53, 3
    s_lshl_b32 s56, s56, 2
    s_add_u32 s56, s56, s48
    s_and_b32 s73, s53, 7
    s_mul_i32 s57, s53, 43
    s_add_u32 s57, s57, 8
    s_lshr_b32 s57, s57, 4
    s_mul_i32 s67, s55, 17
    s_add_u32 s67, s67, s56
    s_lshl_b32 s67, s67, 7
    s_add_u32 s67, s67, 0x290000
    v_lshlrev_b32 v14, 2, v20
    s_cmp_eq_u32 s56, 0
    s_cselect_b32 s59, 0, 0x1000000
    v_add_u32 v16, s59, v14
    v_add_u32 v9, 0x80, v14
    v_cmp_eq_u32 vcc, 0, v21
    s_nop 1
    v_cndmask_b32 v16, v16, v9, vcc
    s_lshl_b32 s61, s48, 2
    s_add_u32 s61, s61, s52
    s_lshl_b32 s5, s52, 11
    s_add_u32 s5, s5, 0x261000
    s_lshl_b32 s4, s53, 7
    s_add_u32 s4, s4, s5
    s_lshl_b32 s65, s48, 19
    s_lshl_b32 s59, s51, 10
    s_add_u32 s65, s65, s59
    s_lshl_b32 s59, s50, 7
    s_add_u32 s65, s65, s59
    s_lshl_b32 s59, s55, 4
    s_add_u32 s59, s59, s56
    s_lshl_b32 s66, s59, 11
    s_add_u32 s66, s66, 0x400000
    s_mul_i32 s64, s61, 98304
    s_lshl_b32 s59, s53, 11
    s_add_u32 s64, s64, s59
    s_add_u32 s64, s64, 0x600000
    s_add_u32 s37, s64, 0x8000
    s_mov_b32 s36, 0
    s_bfe_u32 s41, s2, 0x30003
    s_mul_i32 s59, s36, 12
    s_mov_b32 s38, 0xa9765320
    s_mov_b32 s39, 0xfdc
    s_lshr_b64 s[86:87], s[38:39], s59
    s_sub_u32 s59, 44, s59
    s_lshl_b64 s[38:39], s[38:39], s59
    s_or_b64 s[38:39], s[38:39], s[86:87]
    s_mul_i32 s59, s53, 43
    s_add_u32 s59, s59, 51
    s_lshr_b32 s59, s59, 4
    s_sub_u32 s59, s59, s57
    s_add_u32 s3, s64, 0x10000
    s_cmp_eq_u32 s59, 3
    s_cselect_b32 s3, s3, 0x1000000
    s_cselect_b32 s79, 0, 0x400000
    s_lshl_b32 s62, s48, 4
    v_add_u32 v32, s62, v18
    v_lshlrev_b32 v33, 5, v19
    v_cvt_f32_u32 v24, v32
    v_add_u32 v33, s51, v33
    v_mul_f32 v24, 0xba000000, v24
    v_cvt_f32_u32 v25, v33
    v_mul_f32 v25, v25, v24
    v_fmamk_f32 v36, v24, 0x00000000, v25
    v_fmamk_f32 v37, v24, 0x43000000, v25
    v_fmamk_f32 v42, v24, 0x43800000, v25
    v_fmamk_f32 v43, v24, 0x43c00000, v25
    v_fmamk_f32 v48, v24, 0x44000000, v25
    v_fmamk_f32 v49, v24, 0x44200000, v25
    v_fmamk_f32 v54, v24, 0x44400000, v25
    v_sin_f32 v40, v36
    v_sin_f32 v41, v37
    v_sin_f32 v46, v42
    v_sin_f32 v47, v43
    v_sin_f32 v52, v48
    v_sin_f32 v53, v49
    v_cos_f32 v38, v36
    v_cos_f32 v39, v37
    v_cos_f32 v44, v42
    v_cos_f32 v45, v43
    v_cos_f32 v50, v48
    v_cos_f32 v51, v49
    v_and_b32 v32, 1, v18
    v_cos_f32 v56, v54
    v_mul_u32_u24 v26, 0x8000, v32
    v_sin_f32 v58, v54
    v_cvt_pk_bf16_f32 v68, v40, v41
    v_cvt_pk_bf16_f32 v69, v46, v47
    v_cvt_pk_bf16_f32 v70, v52, v53
    v_lshl_or_b32 v26, v26, 16, v26
    v_fmamk_f32 v55, v24, 0x44600000, v25
    v_sin_f32 v59, v55
    v_cos_f32 v57, v55
    v_cvt_pk_bf16_f32 v71, v58, v59
    v_cvt_pk_bf16_f32 v64, v38, v39
    v_xor_b32 v72, 0x80008000, v68
    v_cvt_pk_bf16_f32 v65, v44, v45
    v_xor_b32 v73, 0x80008000, v69
    v_cvt_pk_bf16_f32 v66, v50, v51
    v_xor_b32 v74, 0x80008000, v70
    v_cvt_pk_bf16_f32 v67, v56, v57
    v_xor_b32 v75, 0x80008000, v71
    v_xor_b32 v76, v26, v64
    v_xor_b32 v80, v26, v68
    v_xor_b32 v84, v26, v72
    v_xor_b32 v77, v26, v65
    v_xor_b32 v81, v26, v69
    v_xor_b32 v85, v26, v73
    v_xor_b32 v78, v26, v66
    v_xor_b32 v82, v26, v70
    v_xor_b32 v86, v26, v74
    v_xor_b32 v79, v26, v67
    v_xor_b32 v83, v26, v71
    v_xor_b32 v87, v26, v75
    s_mul_i32 s59, s48, 6144
    s_add_u32 s59, s59, 0x1d000
    v_add_u32 v22, s59, v2
    ds_write_b128 v22, v[64:67] offset:0
    ds_write_b128 v22, v[68:71] offset:1024
    ds_write_b128 v22, v[72:75] offset:2048
    ds_write_b128 v22, v[76:79] offset:3072
    ds_write_b128 v22, v[80:83] offset:4096
    ds_write_b128 v22, v[84:87] offset:5120
    s_lshl_b32 s59, s48, 2
    s_add_u32 s59, s59, 0x27000
    v_mov_b32 v8, s59
    s_and_b32 s59, s73, 4
    s_lshl_b32 s59, s59, 7
    s_add_u32 s85, s85, s59
    v_bfe_u32 v22, v1, 4, 1
    v_lshlrev_b32 v23, 3, v22
    v_lshl_add_u32 v23, v21, 2, v23
    v_bfe_u32 v22, v1, 2, 2
    v_add_u32 v23, v23, v22
    v_mul_u32_u24 v3, 2752, v23
    v_and_b32 v22, 3, v1
    v_lshl_add_u32 v3, v22, 4, v3
    s_lshl_b32 s70, s57, 6
    s_mul_i32 s76, s48, 44032
    s_add_u32 s70, s76, s70
    s_mov_b32 s76, s70
    s_mov_b32 s81, 176128
    s_lshl_b32 s71, s48, 10
    v_lshrrev_b32 v22, 3, v1
    v_and_b32 v23, 3, v22
    v_lshrrev_b32 v24, 2, v22
    v_lshl_add_u32 v23, v24, 3, v23
    v_lshlrev_b32 v4, 10, v23
    v_and_b32 v22, 2, v22
    v_and_b32 v23, 7, v1
    v_xor_b32 v22, v22, v23
    v_lshl_add_u32 v4, v22, 4, v4
    s_lshr_b32 s75, s48, 1
    s_lshl_b32 s75, s75, 14
    s_and_b32 s59, s48, 1
    s_lshl_b32 s59, s59, 12
    s_add_u32 s75, s75, s59
    s_lshl_b32 s59, s73, 7
    s_add_u32 s75, s75, s59
    s_waitcnt lgkmcnt(0)
    buffer_store_dwordx4 v[252:255], v17, s[28:31], s65 offen sc1
    buffer_store_dwordx4 v[252:255], v12, s[28:31], s65 offen sc1
    s_mov_b64 exec, 0xffff
    buffer_store_dword v252, v35, s[28:31], s32 offen sc1
    s_mov_b64 exec, -1
    s_barrier
    s_waitcnt vmcnt(0)
    s_add_u32 s33, s33, 0x9e3779b1
    s_lshl_b32 s74, s2, 4
    s_add_u32 s74, s74, 0x282000
    v_mov_b32 v13, s33
    v_mov_b32 v28, 1
    s_mov_b64 exec, 1
    ds_add_rtn_u32 v29, v6, v28 offset:40
    s_waitcnt lgkmcnt(0)
    v_cmp_ne_u32 vcc, 3, v29
    s_nop 0
    s_cbranch_vccnz L_c38
    s_mov_b64 exec, 15
    buffer_store_dword v13, v14, s[28:31], s74 offen sc1
L_c38:
    s_mov_b64 exec, -1
    buffer_store_dwordx4 v[252:255], v2, s[28:31], s66 offen sc1
    buffer_store_dwordx4 v[252:255], v2, s[28:31], s66 offen offset:1024 sc1
    buffer_store_dword v252, v16, s[28:31], s67 offen sc1
    s_add_u32 m0, s71, 0x0
    s_add_u32 s76, s41, 0
    s_and_b32 s76, s76, 7
    s_mul_i32 s76, s76, s81
    s_add_u32 s76, s76, s70
    s_add_u32 s80, s76, s79
    buffer_load_dwordx4 v3, s[12:15], s76 offen offset:0 lds
    s_addk_i32 m0, 0xfc0
    s_nop 0
    buffer_load_dwordx4 v3, s[12:15], s76 offen offset:64 lds
    s_addk_i32 m0, 0xfc0
    s_nop 0
    buffer_load_dwordx4 v3, s[12:15], s80 offen offset:128 lds
    s_addk_i32 m0, 0x1080
    s_nop 0
    buffer_load_dwordx4 v3, s[16:19], s76 offen offset:0 lds
    s_addk_i32 m0, 0xfc0
    s_nop 0
    buffer_load_dwordx4 v3, s[16:19], s76 offen offset:64 lds
    buffer_load_dwordx4 v[128:131], v3, s[16:19], s80 offen offset:128
    s_barrier
    v_mov_b32 v28, 1
    s_mov_b64 exec, 1
    s_waitcnt vmcnt(6)
    ds_add_rtn_u32 v29, v6, v28 offset:44
    s_waitcnt lgkmcnt(0)
    v_cmp_ne_u32 vcc, 3, v29
    s_nop 0
    s_cbranch_vccnz L_c39
    s_add_u32 s74, s4, 0x80000
    s_mov_b64 exec, 0xffffffff
    buffer_store_dword v13, v14, s[28:31], s74 offen sc1
L_c39:
    s_mov_b64 exec, -1
    s_waitcnt vmcnt(0)
    s_nop 0
    v_add_u32 v32, s71, v2
    s_mov_b32 s63, 0
L_s37:
    s_sleep 1
    ds_read_b32 v29, v6 offset:32
    s_waitcnt lgkmcnt(0)
    v_cmp_gt_u32 vcc, 4, v29
    s_add_u32 s63, s63, 1
    s_cmp_gt_u32 s63, 100000
    s_cbranch_scc1 L_x37
    s_cbranch_vccnz L_s37
L_x37:
    s_addk_i32 m0, 0x1040
    s_add_u32 s76, s41, 1
    s_and_b32 s76, s76, 7
    s_mul_i32 s76, s76, s81
    s_add_u32 s76, s76, s70
    s_add_u32 s80, s76, s79
    buffer_load_dwordx4 v3, s[12:15], s76 offen offset:0 lds
    s_addk_i32 m0, 0xfc0
    s_nop 0
    buffer_load_dwordx4 v3, s[12:15], s76 offen offset:64 lds
    s_addk_i32 m0, 0xfc0
    s_nop 0
    buffer_load_dwordx4 v3, s[12:15], s80 offen offset:128 lds
    s_waitcnt vmcnt(8)
    s_addk_i32 m0, 0x3080
    s_add_u32 s76, s41, 2
    s_and_b32 s76, s76, 7
    s_mul_i32 s76, s76, s81
    s_add_u32 s76, s76, s70
    s_add_u32 s80, s76, s79
    buffer_load_dwordx4 v3, s[12:15], s76 offen offset:0 lds
    s_addk_i32 m0, 0xfc0
    s_nop 0
    buffer_load_dwordx4 v3, s[12:15], s76 offen offset:64 lds
    s_addk_i32 m0, 0xfc0
    s_nop 0
    buffer_load_dwordx4 v3, s[12:15], s80 offen offset:128 lds
    s_waitcnt vmcnt(8)
    s_addk_i32 m0, 0x3080
    s_add_u32 s76, s41, 3
    s_and_b32 s76, s76, 7
    s_mul_i32 s76, s76, s81
    s_add_u32 s76, s76, s70
    s_add_u32 s80, s76, s79
    buffer_load_dwordx4 v3, s[12:15], s76 offen offset:0 lds
    s_addk_i32 m0, 0xfc0
    s_nop 0
    buffer_load_dwordx4 v3, s[12:15], s76 offen offset:64 lds
    s_addk_i32 m0, 0xfc0
    s_nop 0
    buffer_load_dwordx4 v3, s[12:15], s80 offen offset:128 lds
    s_waitcnt vmcnt(8)
    s_addk_i32 m0, 0x3080
    s_add_u32 s76, s41, 4
    s_and_b32 s76, s76, 7
    s_mul_i32 s76, s76, s81
    s_add_u32 s76, s76, s70
    s_add_u32 s80, s76, s79
    buffer_load_dwordx4 v3, s[12:15], s76 offen offset:0 lds
    s_addk_i32 m0, 0xfc0
    s_nop 0
    buffer_load_dwordx4 v3, s[12:15], s76 offen offset:64 lds
    s_addk_i32 m0, 0xfc0
    s_nop 0
    buffer_load_dwordx4 v3, s[12:15], s80 offen offset:128 lds
    s_waitcnt vmcnt(8)
    s_addk_i32 m0, 0x3080
    s_add_u32 s76, s41, 5
    s_and_b32 s76, s76, 7
    s_mul_i32 s76, s76, s81
    s_add_u32 s76, s76, s70
    s_add_u32 s80, s76, s79
    buffer_load_dwordx4 v3, s[12:15], s76 offen offset:0 lds
    s_addk_i32 m0, 0xfc0
    s_nop 0
    buffer_load_dwordx4 v3, s[12:15], s76 offen offset:64 lds
    s_addk_i32 m0, 0xfc0
    s_nop 0
    buffer_load_dwordx4 v3, s[12:15], s80 offen offset:128 lds
    s_waitcnt vmcnt(8)
    s_mov_b32 s63, 0
L_s38:
    s_sleep 1
    ds_read_b128 v[24:27], v6 offset:16
    s_waitcnt lgkmcnt(0)
    v_min3_u32 v24, v24, v25, v26
    v_min_u32 v24, v24, v27
    v_cmp_gt_u32 vcc, 1, v24
    s_add_u32 s63, s63, 1
    s_cmp_gt_u32 s63, 100000
    s_cbranch_scc1 L_x38
    s_cbranch_vccnz L_s38
L_x38:
    s_addk_i32 m0, 0x3080
    s_add_u32 s76, s41, 6
    s_and_b32 s76, s76, 7
    s_mul_i32 s76, s76, s81
    s_add_u32 s76, s76, s70
    s_add_u32 s80, s76, s79
    buffer_load_dwordx4 v3, s[12:15], s76 offen offset:0 lds
    s_addk_i32 m0, 0xfc0
    s_nop 0
    buffer_load_dwordx4 v3, s[12:15], s76 offen offset:64 lds
    s_addk_i32 m0, 0xfc0
    s_nop 0
    buffer_load_dwordx4 v3, s[12:15], s80 offen offset:128 lds
    s_waitcnt vmcnt(8)
    s_addk_i32 m0, 0x3080
    s_add_u32 s76, s41, 7
    s_and_b32 s76, s76, 7
    s_mul_i32 s76, s76, s81
    s_add_u32 s76, s76, s70
    s_add_u32 s80, s76, s79
    buffer_load_dwordx4 v3, s[12:15], s76 offen offset:0 lds
    s_addk_i32 m0, 0xfc0
    s_nop 0
    buffer_load_dwordx4 v3, s[12:15], s76 offen offset:64 lds
    s_addk_i32 m0, 0xfc0
    s_nop 0
    buffer_load_dwordx4 v3, s[12:15], s80 offen offset:128 lds
    s_waitcnt vmcnt(8)
    s_add_u32 m0, s71, 0x8000
    s_add_u32 s76, s41, 1
    s_and_b32 s76, s76, 7
    s_mul_i32 s76, s76, s81
    s_add_u32 s76, s76, s70
    s_add_u32 s80, s76, s79
    buffer_load_dwordx4 v3, s[16:19], s76 offen offset:0 lds
    s_addk_i32 m0, 0xfc0
    s_nop 0
    buffer_load_dwordx4 v3, s[16:19], s76 offen offset:64 lds
    buffer_load_dwordx4 v[132:135], v3, s[16:19], s80 offen offset:128
    s_waitcnt vmcnt(8)
    s_addk_i32 m0, 0x4040
    s_add_u32 s76, s41, 2
    s_and_b32 s76, s76, 7
    s_mul_i32 s76, s76, s81
    s_add_u32 s76, s76, s70
    s_add_u32 s80, s76, s79
    buffer_load_dwordx4 v3, s[16:19], s76 offen offset:0 lds
    s_addk_i32 m0, 0xfc0
    s_nop 0
    buffer_load_dwordx4 v3, s[16:19], s76 offen offset:64 lds
    buffer_load_dwordx4 v[136:139], v3, s[16:19], s80 offen offset:128
    s_waitcnt vmcnt(8)
    v_mov_b32 v28, 8
    s_waitcnt vmcnt(6)
    ds_write_b32 v8, v28
    s_addk_i32 m0, 0x4040
    s_add_u32 s76, s41, 3
    s_and_b32 s76, s76, 7
    s_mul_i32 s76, s76, s81
    s_add_u32 s76, s76, s70
    s_add_u32 s80, s76, s79
    buffer_load_dwordx4 v3, s[16:19], s76 offen offset:0 lds
    s_addk_i32 m0, 0xfc0
    s_nop 0
    buffer_load_dwordx4 v3, s[16:19], s76 offen offset:64 lds
    buffer_load_dwordx4 v[140:143], v3, s[16:19], s80 offen offset:128
    s_waitcnt vmcnt(8)
    s_addk_i32 m0, 0x4040
    s_add_u32 s76, s41, 4
    s_and_b32 s76, s76, 7
    s_mul_i32 s76, s76, s81
    s_add_u32 s76, s76, s70
    s_add_u32 s80, s76, s79
    buffer_load_dwordx4 v3, s[16:19], s76 offen offset:0 lds
    s_addk_i32 m0, 0xfc0
    s_nop 0
    buffer_load_dwordx4 v3, s[16:19], s76 offen offset:64 lds
    buffer_load_dwordx4 v[144:147], v3, s[16:19], s80 offen offset:128
    s_waitcnt vmcnt(8)
    s_addk_i32 m0, 0x4040
    s_add_u32 s76, s41, 5
    s_and_b32 s76, s76, 7
    s_mul_i32 s76, s76, s81
    s_add_u32 s76, s76, s70
    s_add_u32 s80, s76, s79
    buffer_load_dwordx4 v3, s[16:19], s76 offen offset:0 lds
    s_addk_i32 m0, 0xfc0
    s_nop 0
    buffer_load_dwordx4 v3, s[16:19], s76 offen offset:64 lds
    buffer_load_dwordx4 v[148:151], v3, s[16:19], s80 offen offset:128
    s_waitcnt vmcnt(8)
    s_addk_i32 m0, 0x4040
    s_add_u32 s76, s41, 6
    s_and_b32 s76, s76, 7
    s_mul_i32 s76, s76, s81
    s_add_u32 s76, s76, s70
    s_add_u32 s80, s76, s79
    buffer_load_dwordx4 v3, s[16:19], s76 offen offset:0 lds
    s_addk_i32 m0, 0xfc0
    s_nop 0
    buffer_load_dwordx4 v3, s[16:19], s76 offen offset:64 lds
    buffer_load_dwordx4 v[152:155], v3, s[16:19], s80 offen offset:128
    s_waitcnt vmcnt(8)
    s_addk_i32 m0, 0x4040
    s_add_u32 s76, s41, 7
    s_and_b32 s76, s76, 7
    s_mul_i32 s76, s76, s81
    s_add_u32 s76, s76, s70
    s_add_u32 s80, s76, s79
    buffer_load_dwordx4 v3, s[16:19], s76 offen offset:0 lds
    buffer_load_dwordx4 v[160:163], v3, s[16:19], s76 offen offset:64
    buffer_load_dwordx4 v[156:159], v3, s[16:19], s80 offen offset:128
    v_mov_b32 v28, 9
    s_waitcnt vmcnt(2)
    ds_write_b32 v8, v28
    v_add_u32 v33, 0x10000, v32
    v_add_u32 v34, 0x20000, v32
    s_mov_b32 s63, 0
L_s39:
    s_sleep 1
    ds_read_b128 v[24:27], v6 offset:16
    s_waitcnt lgkmcnt(0)
    v_min3_u32 v24, v24, v25, v26
    v_min_u32 v24, v24, v27
    v_cmp_gt_u32 vcc, 2, v24
    s_add_u32 s63, s63, 1
    s_cmp_gt_u32 s63, 100000
    s_cbranch_scc1 L_x39
    s_cbranch_vccnz L_s39
L_x39:
    s_waitcnt vmcnt(1)
    ds_write_b128 v32, v[160:163] offset:0
    ds_write_b128 v32, v[128:131] offset:4096
    ds_write_b128 v32, v[132:135] offset:20480
    ds_write_b128 v32, v[136:139] offset:24576
    s_mov_b32 s63, 0
L_s40:
    s_sleep 1
    ds_read_b128 v[24:27], v6 offset:16
    s_waitcnt lgkmcnt(0)
    v_min3_u32 v24, v24, v25, v26
    v_min_u32 v24, v24, v27
    v_cmp_gt_u32 vcc, 3, v24
    s_add_u32 s63, s63, 1
    s_cmp_gt_u32 s63, 100000
    s_cbranch_scc1 L_x40
    s_cbranch_vccnz L_s40
L_x40:
    ds_write_b128 v32, v[140:143] offset:40960
    ds_write_b128 v32, v[144:147] offset:45056
    ds_write_b128 v32, v[148:151] offset:61440
    ds_write_b128 v33, v[152:155] offset:0
    s_mov_b32 s63, 0
L_s41:
    s_sleep 1
    ds_read_b128 v[24:27], v6 offset:16
    s_waitcnt lgkmcnt(0)
    v_min3_u32 v24, v24, v25, v26
    v_min_u32 v24, v24, v27
    v_cmp_gt_u32 vcc, 4, v24
    s_add_u32 s63, s63, 1
    s_cmp_gt_u32 s63, 100000
    s_cbranch_scc1 L_x41
    s_cbranch_vccnz L_s41
L_x41:
    buffer_store_dwordx4 v[252:255], v2, s[28:31], s64 offen offset:0 sc1
    buffer_store_dwordx4 v[252:255], v2, s[28:31], s64 offen offset:1024 sc1
    buffer_store_dwordx4 v[252:255], v2, s[28:31], s37 offen offset:0 sc1
    buffer_store_dwordx4 v[252:255], v2, s[28:31], s37 offen offset:1024 sc1
    buffer_store_dwordx4 v[252:255], v2, s[28:31], s3 offen offset:0 sc1
    buffer_store_dwordx4 v[252:255], v2, s[28:31], s3 offen offset:1024 sc1
    s_waitcnt vmcnt(6)
    ds_write_b128 v33, v[156:159] offset:16384
    s_add_u32 m0, s71, 0x15000
    s_add_u32 s77, s75, 0x0
    buffer_load_dwordx4 v4, s[20:23], s77 offen lds
    s_addk_i32 m0, 0x4000
    s_add_u32 s77, s75, 0x18000
    buffer_load_dwordx4 v4, s[20:23], s77 offen lds
    s_addk_i32 m0, 0x1000
    s_add_u32 s77, s75, 0x28000
    buffer_load_dwordx4 v4, s[20:23], s77 offen lds
    v_mov_b32 v28, 11
    s_waitcnt lgkmcnt(0)
    ds_write_b32 v8, v28
    s_lshl_b32 s74, s48, 13
    s_add_u32 s74, s74, s4
    s_add_u32 s74, s74, 0xbf000
    s_mov_b64 exec, 0xffffffff
    s_waitcnt vmcnt(3)
    buffer_store_dword v13, v14, s[28:31], s74 offen sc1
    s_mov_b64 exec, -1
    v_mov_b32 v28, 12
    ds_write_b32 v8, v28
    s_mov_b32 s63, 0
L_s42:
    s_sleep 1
    ds_read_b128 v[24:27], v6 offset:16
    s_waitcnt lgkmcnt(0)
    v_min3_u32 v24, v24, v25, v26
    v_min_u32 v24, v24, v27
    v_cmp_gt_u32 vcc, 5, v24
    s_add_u32 s63, s63, 1
    s_cmp_gt_u32 s63, 100000
    s_cbranch_scc1 L_x42
    s_cbranch_vccnz L_s42
L_x42:
    s_mov_b32 exec_hi, 0xfff
    buffer_load_dword v15, v7, s[20:23], s85 offen
    s_mov_b64 exec, -1
    s_addk_i32 m0, 0x4000
    s_add_u32 s77, s75, 0x40000
    buffer_load_dwordx4 v4, s[20:23], s77 offen lds
    s_addk_i32 m0, 0x1000
    s_add_u32 s77, s75, 0x58000
    buffer_load_dwordx4 v4, s[20:23], s77 offen lds
    s_addk_i32 m0, 0x4000
    s_add_u32 s77, s75, 0x68000
    buffer_load_dwordx4 v4, s[20:23], s77 offen lds
    s_addk_i32 m0, 0x1000
    s_add_u32 s77, s75, 0x80000
    buffer_load_dwordx4 v4, s[20:23], s77 offen lds
    s_add_u32 s77, s75, 0x148000
    buffer_load_dwordx4 v[208:211], v4, s[20:23], s77 offen
    s_add_u32 s77, s75, 0x10000
    buffer_load_dwordx4 v[204:207], v4, s[20:23], s77 offen
    s_add_u32 s77, s75, 0x38000
    buffer_load_dwordx4 v[200:203], v4, s[20:23], s77 offen
    s_add_u32 s77, s75, 0x50000
    buffer_load_dwordx4 v[196:199], v4, s[20:23], s77 offen
    s_mov_b32 s63, 0
L_s43:
    s_sleep 1
    ds_read_b128 v[24:27], v6 offset:16
    s_waitcnt lgkmcnt(0)
    v_min3_u32 v24, v24, v25, v26
    v_min_u32 v24, v24, v27
    v_cmp_gt_u32 vcc, 6, v24
    s_add_u32 s63, s63, 1
    s_cmp_gt_u32 s63, 100000
    s_cbranch_scc1 L_x43
    s_cbranch_vccnz L_s43
L_x43:
    s_add_u32 m0, s71, 0x3000
    s_add_u32 s77, s75, 0x98000
    buffer_load_dwordx4 v4, s[20:23], s77 offen lds
    s_addk_i32 m0, 0x5000
    s_add_u32 s77, s75, 0xb0000
    buffer_load_dwordx4 v4, s[20:23], s77 offen lds
    s_addk_i32 m0, 0x5000
    s_add_u32 s77, s75, 0xc0000
    buffer_load_dwordx4 v4, s[20:23], s77 offen lds
    s_addk_i32 m0, 0x5000
    s_add_u32 s77, s75, 0xd8000
    buffer_load_dwordx4 v4, s[20:23], s77 offen lds
    s_add_u32 s77, s75, 0x78000
    buffer_load_dwordx4 v[192:195], v4, s[20:23], s77 offen
    s_add_u32 s77, s75, 0x90000
    buffer_load_dwordx4 v[188:191], v4, s[20:23], s77 offen
    s_add_u32 s77, s75, 0xa8000
    buffer_load_dwordx4 v[184:187], v4, s[20:23], s77 offen
    s_add_u32 s77, s75, 0xd0000
    buffer_load_dwordx4 v[180:183], v4, s[20:23], s77 offen
    s_mov_b32 s63, 0
L_s44:
    s_sleep 1
    ds_read_b128 v[24:27], v6 offset:16
    s_waitcnt lgkmcnt(0)
    v_min3_u32 v24, v24, v25, v26
    v_min_u32 v24, v24, v27
    v_cmp_gt_u32 vcc, 7, v24
    s_add_u32 s63, s63, 1
    s_cmp_gt_u32 s63, 100000
    s_cbranch_scc1 L_x44
    s_cbranch_vccnz L_s44
L_x44:
    s_addk_i32 m0, 0x5000
    s_add_u32 s77, s75, 0xf0000
    buffer_load_dwordx4 v4, s[20:23], s77 offen lds
    s_addk_i32 m0, 0x5000
    s_add_u32 s77, s75, 0x100000
    buffer_load_dwordx4 v4, s[20:23], s77 offen lds
    s_addk_i32 m0, 0x5000
    s_add_u32 s77, s75, 0x118000
    buffer_load_dwordx4 v4, s[20:23], s77 offen lds
    s_addk_i32 m0, 0x5000
    s_add_u32 s77, s75, 0x130000
    buffer_load_dwordx4 v4, s[20:23], s77 offen lds
    s_add_u32 s77, s75, 0xe8000
    buffer_load_dwordx4 v[176:179], v4, s[20:23], s77 offen
    s_add_u32 s77, s75, 0x110000
    buffer_load_dwordx4 v[172:175], v4, s[20:23], s77 offen
    s_add_u32 s77, s75, 0x128000
    buffer_load_dwordx4 v[168:171], v4, s[20:23], s77 offen
    s_add_u32 s77, s75, 0x150000
    buffer_load_dwordx4 v[164:167], v4, s[20:23], s77 offen
    v_mov_b32 v28, 14
    s_waitcnt vmcnt(12)
    ds_write_b32 v8, v28
    s_mov_b32 s63, 0
L_s45:
    s_sleep 1
    ds_read_b128 v[24:27], v6 offset:16
    s_waitcnt lgkmcnt(0)
    v_min3_u32 v24, v24, v25, v26
    v_min_u32 v24, v24, v27
    v_cmp_gt_u32 vcc, 8, v24
    s_add_u32 s63, s63, 1
    s_cmp_gt_u32 s63, 100000
    s_cbranch_scc1 L_x45
    s_cbranch_vccnz L_s45
L_x45:
    s_add_u32 m0, s71, 0x2000
    s_add_u32 s77, s75, 0x140000
    buffer_load_dwordx4 v4, s[20:23], s77 offen lds
    s_addk_i32 m0, 0x5000
    s_add_u32 s77, s75, 0x8000
    buffer_load_dwordx4 v4, s[20:23], s77 offen lds
    s_addk_i32 m0, 0x5000
    s_add_u32 s77, s75, 0x20000
    buffer_load_dwordx4 v4, s[20:23], s77 offen lds
    s_addk_i32 m0, 0x5000
    s_add_u32 s77, s75, 0x30000
    buffer_load_dwordx4 v4, s[20:23], s77 offen lds
    s_mov_b32 s63, 0
L_s46:
    s_sleep 1
    ds_read_b128 v[24:27], v6 offset:16
    s_waitcnt lgkmcnt(0)
    v_min3_u32 v24, v24, v25, v26
    v_min_u32 v24, v24, v27
    v_cmp_gt_u32 vcc, 9, v24
    s_add_u32 s63, s63, 1
    s_cmp_gt_u32 s63, 100000
    s_cbranch_scc1 L_x46
    s_cbranch_vccnz L_s46
L_x46:
    s_addk_i32 m0, 0x5000
    s_add_u32 s77, s75, 0x48000
    buffer_load_dwordx4 v4, s[20:23], s77 offen lds
    s_addk_i32 m0, 0x5000
    s_add_u32 s77, s75, 0x60000
    buffer_load_dwordx4 v4, s[20:23], s77 offen lds
    s_addk_i32 m0, 0x5000
    s_add_u32 s77, s75, 0x70000
    buffer_load_dwordx4 v4, s[20:23], s77 offen lds
    s_addk_i32 m0, 0x5000
    s_add_u32 s77, s75, 0x88000
    buffer_load_dwordx4 v4, s[20:23], s77 offen lds
    v_mov_b32 v28, 16
    s_waitcnt vmcnt(4)
    ds_write_b32 v8, v28
    s_mov_b32 s63, 0
L_s47:
    s_sleep 1
    ds_read_b128 v[24:27], v6 offset:16
    s_waitcnt lgkmcnt(0)
    v_min3_u32 v24, v24, v25, v26
    v_min_u32 v24, v24, v27
    v_cmp_gt_u32 vcc, 10, v24
    s_add_u32 s63, s63, 1
    s_cmp_gt_u32 s63, 100000
    s_cbranch_scc1 L_x47
    s_cbranch_vccnz L_s47
L_x47:
    s_add_u32 m0, s71, 0x4000
    s_add_u32 s77, s75, 0xa0000
    buffer_load_dwordx4 v4, s[20:23], s77 offen lds
    s_addk_i32 m0, 0x5000
    s_add_u32 s77, s75, 0xb8000
    buffer_load_dwordx4 v4, s[20:23], s77 offen lds
    s_addk_i32 m0, 0x5000
    s_add_u32 s77, s75, 0xc8000
    buffer_load_dwordx4 v4, s[20:23], s77 offen lds
    s_addk_i32 m0, 0x5000
    s_add_u32 s77, s75, 0xe0000
    buffer_load_dwordx4 v4, s[20:23], s77 offen lds
    s_mov_b32 s63, 0
L_s48:
    s_sleep 1
    ds_read_b128 v[24:27], v6 offset:16
    s_waitcnt lgkmcnt(0)
    v_min3_u32 v24, v24, v25, v26
    v_min_u32 v24, v24, v27
    v_cmp_gt_u32 vcc, 11, v24
    s_add_u32 s63, s63, 1
    s_cmp_gt_u32 s63, 100000
    s_cbranch_scc1 L_x48
    s_cbranch_vccnz L_s48
L_x48:
    s_addk_i32 m0, 0x5000
    s_add_u32 s77, s75, 0xf8000
    buffer_load_dwordx4 v4, s[20:23], s77 offen lds
    s_addk_i32 m0, 0x5000
    s_add_u32 s77, s75, 0x108000
    buffer_load_dwordx4 v4, s[20:23], s77 offen lds
    s_addk_i32 m0, 0x5000
    s_add_u32 s77, s75, 0x120000
    buffer_load_dwordx4 v4, s[20:23], s77 offen lds
    s_add_u32 m0, s71, 0x0
    s_add_u32 s77, s75, 0x138000
    buffer_load_dwordx4 v4, s[20:23], s77 offen lds
    v_mov_b32 v28, 18
    s_waitcnt vmcnt(4)
    ds_write_b32 v8, v28
    s_mov_b32 s63, 0
L_s49:
    s_sleep 1
    ds_read_b128 v[24:27], v6 offset:16
    s_waitcnt lgkmcnt(0)
    v_min3_u32 v24, v24, v25, v26
    v_min_u32 v24, v24, v27
    v_cmp_gt_u32 vcc, 12, v24
    s_add_u32 s63, s63, 1
    s_cmp_gt_u32 s63, 100000
    s_cbranch_scc1 L_x49
    s_cbranch_vccnz L_s49
L_x49:
    ds_write_b128 v32, v[208:211] offset:4096
    ds_write_b128 v32, v[204:207] offset:20480
    ds_write_b128 v32, v[200:203] offset:24576
    ds_write_b128 v32, v[196:199] offset:40960
    s_mov_b32 s63, 0
L_s50:
    s_sleep 1
    ds_read_b128 v[24:27], v6 offset:16
    s_waitcnt lgkmcnt(0)
    v_min3_u32 v24, v24, v25, v26
    v_min_u32 v24, v24, v27
    v_cmp_gt_u32 vcc, 13, v24
    s_add_u32 s63, s63, 1
    s_cmp_gt_u32 s63, 100000
    s_cbranch_scc1 L_x50
    s_cbranch_vccnz L_s50
L_x50:
    ds_write_b128 v32, v[192:195] offset:45056
    ds_write_b128 v32, v[188:191] offset:61440
    ds_write_b128 v33, v[184:187] offset:0
    ds_write_b128 v33, v[180:183] offset:16384
    ds_write_b128 v33, v[176:179] offset:20480
    ds_write_b128 v33, v[172:175] offset:36864
    ds_write_b128 v33, v[168:171] offset:40960
    ds_write_b128 v33, v[164:167] offset:57344
    v_mov_b32 v28, 20
    s_waitcnt vmcnt(0) lgkmcnt(0)
    ds_write_b32 v8, v28
    s_or_b32 s59, s48, s2
    s_cbranch_scc1 L_c40
    s_mov_b32 s83, 0x260000
    s_mov_b64 exec, 0xffffffff
    buffer_store_dword v13, v14, s[28:31], s83 offen sc1
L_c40:
    s_mov_b64 exec, -1
L_hend:
    s_endpgm
L_end:
.section .rodata,"a"
.p2align 6
.amdhsa_kernel sequential_preLN__spectral_fnet__swiglu_ffn__prompt_kernel
  .amdhsa_next_free_vgpr 256
  .amdhsa_next_free_sgpr 102
  .amdhsa_accum_offset 256
  .amdhsa_group_segment_fixed_size 0
  .amdhsa_kernarg_size 96
  .amdhsa_user_sgpr_count 2
  .amdhsa_user_sgpr_kernarg_segment_ptr 1
  .amdhsa_system_sgpr_workgroup_id_x 1
.end_amdhsa_kernel
```
